```python
import torch

def _softmax(x, axis=-1):
    return torch.softmax(x, dim=axis)
def _gelu(x):
    return torch.nn.functional.gelu(x, approximate="tanh")
def _silu(x):
    return torch.nn.functional.silu(x)
def _sigmoid(x):
    return torch.sigmoid(x)
def _layernorm(x, axis=-1, eps=1e-5):
    m = x.mean(dim=axis, keepdim=True)
    v = x.var(dim=axis, keepdim=True, unbiased=False)
    return (x - m) / torch.sqrt(v + eps)
def _scatter_add(tgt, idx, src, axis=0):
    return tgt.clone().index_add_(axis, idx, src)
def _segment_sum(src, seg, n):
    out = torch.zeros((n,) + src.shape[1:], dtype=src.dtype)
    return out.index_add_(0, seg, src)
def _pad(x, pw):
    flat = tuple(v for pair in reversed(pw) for v in pair)
    return torch.nn.functional.pad(x, flat)

kernel_name = 'concat_heads__mha_block_cached__gqa_block_cached__decode'

def setup_inputs():

    _w = (lambda a: (lambda t: t.to(torch.bfloat16) if t.is_floating_point() else t)(torch.as_tensor(a)))
    def _A_setup():
        B, Sq, D = 1, 1, 512
        H, Sk, Dh = 32, 8192, 128
        return {
            "x": _w((lambda *s: torch.randn(*s, dtype=torch.bfloat16) * 0.8)(B, Sq, D)),
            "k_cache": _w((lambda *s: torch.randn(*s, dtype=torch.bfloat16) * 0.8)(B, H, Sk, Dh)),
            "v_cache": _w((lambda *s: torch.randn(*s, dtype=torch.bfloat16) * 0.05)(B, H, Sk, Dh)),
            "wq": _w((lambda *s: torch.randn(*s, dtype=torch.bfloat16) * 0.8)(D, H * Dh) * (D ** -0.5)),
            "wo": _w((lambda *s: torch.randn(*s, dtype=torch.bfloat16) * 0.05)(H * Dh, D) * ((H * Dh) ** -0.5)),
        }
    _A_in = _A_setup()

    def _B_setup():
        B, Sq, D = 1, 1, 512
        Hq, Hkv, Sk, Dh = 32, 32, 8192, 128
        assert Hq % Hkv == 0, (Hq, Hkv)
        return {
            "x": _w((lambda *s: torch.randn(*s, dtype=torch.bfloat16) * 0.8)(B, Sq, D)),
            "k_cache": _w((lambda *s: torch.randn(*s, dtype=torch.bfloat16) * 0.8)(B, Hkv, Sk, Dh)),
            "v_cache": _w((lambda *s: torch.randn(*s, dtype=torch.bfloat16) * 0.05)(B, Hkv, Sk, Dh)),
            "wq": _w((lambda *s: torch.randn(*s, dtype=torch.bfloat16) * 0.8)(D, Hq * Dh) * (D ** -0.5)),
            "wo": _w((lambda *s: torch.randn(*s, dtype=torch.bfloat16) * 0.05)(Hq * Dh, D) * ((Hq * Dh) ** -0.5)),
        }
    _B_in = _B_setup()

    return {
        "A_x": _A_in["x"],
        "A_k_cache": _A_in["k_cache"],
        "A_v_cache": _A_in["v_cache"],
        "A_wq": _A_in["wq"],
        "A_wo": _A_in["wo"],
        "B_x": _B_in["x"],
        "B_k_cache": _B_in["k_cache"],
        "B_v_cache": _B_in["v_cache"],
        "B_wq": _B_in["wq"],
        "B_wo": _B_in["wo"],
    }

def reference(A_x, A_k_cache, A_v_cache, A_wq, A_wo, B_x, B_k_cache, B_v_cache, B_wq, B_wo):
    def _A_ref(x, k_cache, v_cache, wq, wo):
        B, Sq, D = x.shape
        H, Dh = 32, 128
        q = (lambda x, *d: x.permute(*d))((x @ wq).reshape(B, Sq, H, Dh), 0, 2, 1, 3)
        scores = torch.einsum("bhqd,bhkd->bhqk", q, k_cache) * (Dh ** -0.5)
        p = _softmax(scores, axis=-1)
        o = torch.einsum("bhqk,bhkd->bhqd", p, v_cache)
        return (lambda x, *d: x.permute(*d))(o, 0, 2, 1, 3).reshape(B, Sq, H * Dh) @ wo

    def _B_ref(x, k_cache, v_cache, wq, wo):
        B, Sq, D = x.shape
        Hq, Dh = 32, 128
        Hkv = k_cache.shape[1]
        rep = Hq // Hkv
        q = (lambda x, *d: x.permute(*d))((x @ wq).reshape(B, Sq, Hq, Dh), 0, 2, 1, 3)
        k = (lambda x, n, axis: torch.repeat_interleave(x, n, dim=axis))(k_cache, rep, axis=1)
        v = (lambda x, n, axis: torch.repeat_interleave(x, n, dim=axis))(v_cache, rep, axis=1)
        scores = torch.einsum("bhqd,bhkd->bhqk", q, k) * (Dh ** -0.5)
        p = _softmax(scores, axis=-1)
        o = torch.einsum("bhqk,bhkd->bhqd", p, v)
        return (lambda x, *d: x.permute(*d))(o, 0, 2, 1, 3).reshape(B, Sq, Hq * Dh) @ wo

    a = _A_ref(A_x, A_k_cache, A_v_cache, A_wq, A_wo)
    b = _B_ref(B_x, B_k_cache, B_v_cache, B_wq, B_wo)
    return torch.concatenate([a, b], axis=-1)
```

```asm
; @launch grid=(256,1,1) block=(512,1,1) lds=28672
.amdgcn_target "amdgcn-amd-amdhsa--gfx950"
.text
    .globl concat_heads__mha_block_cached__gqa_block_cached__decode_kernel
    .p2align 8
    .type concat_heads__mha_block_cached__gqa_block_cached__decode_kernel,@function
concat_heads__mha_block_cached__gqa_block_cached__decode_kernel:
    s_cmp_ge_u32 s2, 256
    s_cbranch_scc1 L_end
    s_load_dwordx16 s[16:31], s[0:1], 0
    s_load_dwordx4 s[32:35], s[0:1], 64
    s_load_dwordx2 s[36:37], s[0:1], 96
    v_lshrrev_b32 v5, 6, v0
    v_and_b32 v1, 63, v0
    s_nop 0
    v_readfirstlane_b32 s3, v5
    s_and_b32 s4, s2, 63
    s_lshr_b32 s5, s2, 6
    s_lshr_b32 s6, s4, 5
    s_and_b32 s7, s4, 31
    v_lshlrev_b32 v2, 4, v1
    v_lshrrev_b32 v5, 4, v1
    v_and_b32 v6, 15, v1
    v_lshlrev_b32 v7, 13, v5
    v_lshl_add_u32 v3, v6, 4, v7
    v_lshl_add_u32 v7, v6, 2, v5
    v_lshlrev_b32 v7, 1, v7
    s_mov_b32 s64, 4096
    s_mov_b32 s65, 0x3fb8aa3b
    s_mov_b32 s66, 0x3db504f3
    s_waitcnt lgkmcnt(0)
    s_cmp_eq_u32 s6, 0
    s_cselect_b64 s[8:9], s[16:17], s[26:27]
    s_cselect_b64 s[10:11], s[18:19], s[28:29]
    s_cselect_b64 s[12:13], s[20:21], s[30:31]
    s_cselect_b64 s[14:15], s[22:23], s[32:33]
    s_cselect_b64 s[38:39], s[24:25], s[34:35]
    s_mov_b32 s21, 8192
    s_mov_b32 s22, 12288
    s_mov_b32 s20, 0
    s_lshl_b32 s67, s3, 7
    s_add_u32 s52, s8, s67
    s_addc_u32 s53, s9, 0
    s_mov_b32 s54, 128
    s_mov_b32 s55, 0x00020000
    s_lshl_b32 s67, s7, 8
    s_lshl_b32 s68, s3, 19
    s_add_u32 s67, s67, s68
    s_add_u32 s44, s14, s67
    s_addc_u32 s45, s15, 0
    s_mov_b32 s46, 516352
    s_mov_b32 s47, 0x00020000
    buffer_load_ushort v4, v7, s[52:55], 0 offen
    s_mov_b32 s67, 0
    buffer_load_dwordx4 v[128:131], v3, s[44:47], s67 offen nt
    s_add_u32 s67, s67, 32768
    buffer_load_dwordx4 v[132:135], v3, s[44:47], s67 offen nt
    s_add_u32 s67, s67, 32768
    buffer_load_dwordx4 v[136:139], v3, s[44:47], s67 offen nt
    s_add_u32 s67, s67, 32768
    buffer_load_dwordx4 v[140:143], v3, s[44:47], s67 offen nt
    s_add_u32 s67, s67, 32768
    buffer_load_dwordx4 v[144:147], v3, s[44:47], s67 offen nt
    s_add_u32 s67, s67, 32768
    buffer_load_dwordx4 v[148:151], v3, s[44:47], s67 offen nt
    s_add_u32 s67, s67, 32768
    buffer_load_dwordx4 v[152:155], v3, s[44:47], s67 offen nt
    s_add_u32 s67, s67, 32768
    buffer_load_dwordx4 v[156:159], v3, s[44:47], s67 offen nt
    s_add_u32 s67, s67, 32768
    buffer_load_dwordx4 v[160:163], v3, s[44:47], s67 offen nt
    s_add_u32 s67, s67, 32768
    buffer_load_dwordx4 v[164:167], v3, s[44:47], s67 offen nt
    s_add_u32 s67, s67, 32768
    buffer_load_dwordx4 v[168:171], v3, s[44:47], s67 offen nt
    s_add_u32 s67, s67, 32768
    buffer_load_dwordx4 v[172:175], v3, s[44:47], s67 offen nt
    s_add_u32 s67, s67, 32768
    buffer_load_dwordx4 v[176:179], v3, s[44:47], s67 offen nt
    s_add_u32 s67, s67, 32768
    buffer_load_dwordx4 v[180:183], v3, s[44:47], s67 offen nt
    s_add_u32 s67, s67, 32768
    buffer_load_dwordx4 v[184:187], v3, s[44:47], s67 offen nt
    s_add_u32 s67, s67, 32768
    buffer_load_dwordx4 v[188:191], v3, s[44:47], s67 offen nt
    s_lshl_b32 s67, s7, 21
    s_lshl_b32 s68, s5, 19
    s_add_u32 s67, s67, s68
    s_lshl_b32 s68, s3, 12
    s_add_u32 s67, s67, s68
    s_add_u32 s60, s10, s67
    s_addc_u32 s61, s11, 0
    s_add_u32 s62, s12, s67
    s_addc_u32 s63, s13, 0
    s_mov_b32 s43, 0x00020000
    s_barrier
    s_and_b32 s67, s20, 15
    s_lshl_b32 s67, s67, 15
    s_cmp_lt_u32 s20, 16
    s_cselect_b64 s[40:41], s[60:61], s[62:63]
    s_add_u32 s40, s40, s67
    s_addc_u32 s41, s41, 0
    s_cmp_lt_u32 s20, 32
    s_cselect_b32 s42, 4096, 0
    s_add_u32 s20, s20, 1
    buffer_load_dwordx4 v[64:67], v2, s[40:43], 0 offen offset:0 nt
    buffer_load_dwordx4 v[68:71], v2, s[40:43], 0 offen offset:1024 nt
    buffer_load_dwordx4 v[72:75], v2, s[40:43], 0 offen offset:2048 nt
    buffer_load_dwordx4 v[76:79], v2, s[40:43], 0 offen offset:3072 nt
    s_load_dwordx4 s[8:11], s[0:1], 80
    s_lshl_b32 s67, s7, 17
    s_lshl_b32 s68, s3, 14
    s_add_u32 s67, s67, s68
    s_add_u32 s48, s38, s67
    s_addc_u32 s49, s39, 0
    s_mov_b32 s50, 16384
    s_mov_b32 s51, 0x00020000
    s_mov_b32 s56, s36
    s_mov_b32 s57, s37
    s_mov_b32 s58, 526336
    s_mov_b32 s59, 0x00020000
    s_mov_b32 s70, 0x00010001
    s_mov_b32 s71, 0x00010001
    s_mov_b32 s72, 0x00020002
    s_mov_b32 s73, 0x00020002
    s_mov_b32 s74, 0x00040004
    s_mov_b32 s75, 0x00040004
    s_mov_b32 s76, 0x00080008
    s_mov_b32 s77, 0x00080008
    s_mov_b32 s78, 0x00100010
    s_mov_b32 s79, 0x00100010
    s_mov_b32 s80, 0x00200020
    s_mov_b32 s81, 0x00200020
    s_mov_b32 s82, 0x00400040
    s_mov_b32 s83, 0x00400040
    s_mov_b32 s84, 0x00800080
    s_mov_b32 s85, 0x00800080
    s_mov_b32 s86, 0x01000100
    s_mov_b32 s87, 0x01000100
    s_mov_b32 s88, 0x02000200
    s_mov_b32 s89, 0x02000200
    s_mov_b32 s90, 0x04000400
    s_mov_b32 s91, 0x04000400
    s_mov_b32 s92, 0x08000800
    s_mov_b32 s93, 0x08000800
    s_mov_b32 s94, 0x10001000
    s_mov_b32 s95, 0x10001000
    s_mov_b32 s96, 0x20002000
    s_mov_b32 s97, 0x20002000
    s_mov_b32 s98, 0x40004000
    s_mov_b32 s99, 0x40004000
    s_mov_b32 s100, 0x80008000
    s_mov_b32 s101, 0x80008000
    v_mov_b32 v32, 0
    v_mov_b32 v33, 0
    v_mov_b32 v34, 0
    v_mov_b32 v35, 0
    v_mov_b32 v36, 0
    v_mov_b32 v37, 0
    v_mov_b32 v38, 0
    v_mov_b32 v39, 0
    s_waitcnt vmcnt(19)
    v_lshlrev_b32 v4, 16, v4
    s_nop 1
    s_waitcnt vmcnt(19)
    v_lshlrev_b32 v24, 16, v128
    v_and_b32 v25, 0xffff0000, v128
    v_lshlrev_b32 v26, 16, v129
    v_and_b32 v27, 0xffff0000, v129
    v_lshlrev_b32 v28, 16, v130
    v_and_b32 v29, 0xffff0000, v130
    v_lshlrev_b32 v30, 16, v131
    v_and_b32 v31, 0xffff0000, v131
    v_fmac_f32_dpp v32, v4, v24 row_newbcast:0 row_mask:0xf bank_mask:0xf
    v_fmac_f32_dpp v33, v4, v25 row_newbcast:0 row_mask:0xf bank_mask:0xf
    v_fmac_f32_dpp v34, v4, v26 row_newbcast:0 row_mask:0xf bank_mask:0xf
    v_fmac_f32_dpp v35, v4, v27 row_newbcast:0 row_mask:0xf bank_mask:0xf
    v_fmac_f32_dpp v36, v4, v28 row_newbcast:0 row_mask:0xf bank_mask:0xf
    v_fmac_f32_dpp v37, v4, v29 row_newbcast:0 row_mask:0xf bank_mask:0xf
    v_fmac_f32_dpp v38, v4, v30 row_newbcast:0 row_mask:0xf bank_mask:0xf
    v_fmac_f32_dpp v39, v4, v31 row_newbcast:0 row_mask:0xf bank_mask:0xf
    s_waitcnt vmcnt(18)
    v_lshlrev_b32 v24, 16, v132
    v_and_b32 v25, 0xffff0000, v132
    v_lshlrev_b32 v26, 16, v133
    v_and_b32 v27, 0xffff0000, v133
    v_lshlrev_b32 v28, 16, v134
    v_and_b32 v29, 0xffff0000, v134
    v_lshlrev_b32 v30, 16, v135
    v_and_b32 v31, 0xffff0000, v135
    v_fmac_f32_dpp v32, v4, v24 row_newbcast:1 row_mask:0xf bank_mask:0xf
    v_fmac_f32_dpp v33, v4, v25 row_newbcast:1 row_mask:0xf bank_mask:0xf
    v_fmac_f32_dpp v34, v4, v26 row_newbcast:1 row_mask:0xf bank_mask:0xf
    v_fmac_f32_dpp v35, v4, v27 row_newbcast:1 row_mask:0xf bank_mask:0xf
    v_fmac_f32_dpp v36, v4, v28 row_newbcast:1 row_mask:0xf bank_mask:0xf
    v_fmac_f32_dpp v37, v4, v29 row_newbcast:1 row_mask:0xf bank_mask:0xf
    v_fmac_f32_dpp v38, v4, v30 row_newbcast:1 row_mask:0xf bank_mask:0xf
    v_fmac_f32_dpp v39, v4, v31 row_newbcast:1 row_mask:0xf bank_mask:0xf
    s_waitcnt vmcnt(17)
    v_lshlrev_b32 v24, 16, v136
    v_and_b32 v25, 0xffff0000, v136
    v_lshlrev_b32 v26, 16, v137
    v_and_b32 v27, 0xffff0000, v137
    v_lshlrev_b32 v28, 16, v138
    v_and_b32 v29, 0xffff0000, v138
    v_lshlrev_b32 v30, 16, v139
    v_and_b32 v31, 0xffff0000, v139
    v_fmac_f32_dpp v32, v4, v24 row_newbcast:2 row_mask:0xf bank_mask:0xf
    v_fmac_f32_dpp v33, v4, v25 row_newbcast:2 row_mask:0xf bank_mask:0xf
    v_fmac_f32_dpp v34, v4, v26 row_newbcast:2 row_mask:0xf bank_mask:0xf
    v_fmac_f32_dpp v35, v4, v27 row_newbcast:2 row_mask:0xf bank_mask:0xf
    v_fmac_f32_dpp v36, v4, v28 row_newbcast:2 row_mask:0xf bank_mask:0xf
    v_fmac_f32_dpp v37, v4, v29 row_newbcast:2 row_mask:0xf bank_mask:0xf
    v_fmac_f32_dpp v38, v4, v30 row_newbcast:2 row_mask:0xf bank_mask:0xf
    v_fmac_f32_dpp v39, v4, v31 row_newbcast:2 row_mask:0xf bank_mask:0xf
    s_waitcnt vmcnt(16)
    v_lshlrev_b32 v24, 16, v140
    v_and_b32 v25, 0xffff0000, v140
    v_lshlrev_b32 v26, 16, v141
    v_and_b32 v27, 0xffff0000, v141
    v_lshlrev_b32 v28, 16, v142
    v_and_b32 v29, 0xffff0000, v142
    v_lshlrev_b32 v30, 16, v143
    v_and_b32 v31, 0xffff0000, v143
    v_fmac_f32_dpp v32, v4, v24 row_newbcast:3 row_mask:0xf bank_mask:0xf
    v_fmac_f32_dpp v33, v4, v25 row_newbcast:3 row_mask:0xf bank_mask:0xf
    v_fmac_f32_dpp v34, v4, v26 row_newbcast:3 row_mask:0xf bank_mask:0xf
    v_fmac_f32_dpp v35, v4, v27 row_newbcast:3 row_mask:0xf bank_mask:0xf
    v_fmac_f32_dpp v36, v4, v28 row_newbcast:3 row_mask:0xf bank_mask:0xf
    v_fmac_f32_dpp v37, v4, v29 row_newbcast:3 row_mask:0xf bank_mask:0xf
    v_fmac_f32_dpp v38, v4, v30 row_newbcast:3 row_mask:0xf bank_mask:0xf
    v_fmac_f32_dpp v39, v4, v31 row_newbcast:3 row_mask:0xf bank_mask:0xf
    s_waitcnt vmcnt(15)
    v_lshlrev_b32 v24, 16, v144
    v_and_b32 v25, 0xffff0000, v144
    v_lshlrev_b32 v26, 16, v145
    v_and_b32 v27, 0xffff0000, v145
    v_lshlrev_b32 v28, 16, v146
    v_and_b32 v29, 0xffff0000, v146
    v_lshlrev_b32 v30, 16, v147
    v_and_b32 v31, 0xffff0000, v147
    v_fmac_f32_dpp v32, v4, v24 row_newbcast:4 row_mask:0xf bank_mask:0xf
    v_fmac_f32_dpp v33, v4, v25 row_newbcast:4 row_mask:0xf bank_mask:0xf
    v_fmac_f32_dpp v34, v4, v26 row_newbcast:4 row_mask:0xf bank_mask:0xf
    v_fmac_f32_dpp v35, v4, v27 row_newbcast:4 row_mask:0xf bank_mask:0xf
    v_fmac_f32_dpp v36, v4, v28 row_newbcast:4 row_mask:0xf bank_mask:0xf
    v_fmac_f32_dpp v37, v4, v29 row_newbcast:4 row_mask:0xf bank_mask:0xf
    v_fmac_f32_dpp v38, v4, v30 row_newbcast:4 row_mask:0xf bank_mask:0xf
    v_fmac_f32_dpp v39, v4, v31 row_newbcast:4 row_mask:0xf bank_mask:0xf
    s_waitcnt vmcnt(14)
    v_lshlrev_b32 v24, 16, v148
    v_and_b32 v25, 0xffff0000, v148
    v_lshlrev_b32 v26, 16, v149
    v_and_b32 v27, 0xffff0000, v149
    v_lshlrev_b32 v28, 16, v150
    v_and_b32 v29, 0xffff0000, v150
    v_lshlrev_b32 v30, 16, v151
    v_and_b32 v31, 0xffff0000, v151
    v_fmac_f32_dpp v32, v4, v24 row_newbcast:5 row_mask:0xf bank_mask:0xf
    v_fmac_f32_dpp v33, v4, v25 row_newbcast:5 row_mask:0xf bank_mask:0xf
    v_fmac_f32_dpp v34, v4, v26 row_newbcast:5 row_mask:0xf bank_mask:0xf
    v_fmac_f32_dpp v35, v4, v27 row_newbcast:5 row_mask:0xf bank_mask:0xf
    v_fmac_f32_dpp v36, v4, v28 row_newbcast:5 row_mask:0xf bank_mask:0xf
    v_fmac_f32_dpp v37, v4, v29 row_newbcast:5 row_mask:0xf bank_mask:0xf
    v_fmac_f32_dpp v38, v4, v30 row_newbcast:5 row_mask:0xf bank_mask:0xf
    v_fmac_f32_dpp v39, v4, v31 row_newbcast:5 row_mask:0xf bank_mask:0xf
    s_waitcnt vmcnt(13)
    v_lshlrev_b32 v24, 16, v152
    v_and_b32 v25, 0xffff0000, v152
    v_lshlrev_b32 v26, 16, v153
    v_and_b32 v27, 0xffff0000, v153
    v_lshlrev_b32 v28, 16, v154
    v_and_b32 v29, 0xffff0000, v154
    v_lshlrev_b32 v30, 16, v155
    v_and_b32 v31, 0xffff0000, v155
    v_fmac_f32_dpp v32, v4, v24 row_newbcast:6 row_mask:0xf bank_mask:0xf
    v_fmac_f32_dpp v33, v4, v25 row_newbcast:6 row_mask:0xf bank_mask:0xf
    v_fmac_f32_dpp v34, v4, v26 row_newbcast:6 row_mask:0xf bank_mask:0xf
    v_fmac_f32_dpp v35, v4, v27 row_newbcast:6 row_mask:0xf bank_mask:0xf
    v_fmac_f32_dpp v36, v4, v28 row_newbcast:6 row_mask:0xf bank_mask:0xf
    v_fmac_f32_dpp v37, v4, v29 row_newbcast:6 row_mask:0xf bank_mask:0xf
    v_fmac_f32_dpp v38, v4, v30 row_newbcast:6 row_mask:0xf bank_mask:0xf
    v_fmac_f32_dpp v39, v4, v31 row_newbcast:6 row_mask:0xf bank_mask:0xf
    s_waitcnt vmcnt(12)
    v_lshlrev_b32 v24, 16, v156
    v_and_b32 v25, 0xffff0000, v156
    v_lshlrev_b32 v26, 16, v157
    v_and_b32 v27, 0xffff0000, v157
    v_lshlrev_b32 v28, 16, v158
    v_and_b32 v29, 0xffff0000, v158
    v_lshlrev_b32 v30, 16, v159
    v_and_b32 v31, 0xffff0000, v159
    v_fmac_f32_dpp v32, v4, v24 row_newbcast:7 row_mask:0xf bank_mask:0xf
    v_fmac_f32_dpp v33, v4, v25 row_newbcast:7 row_mask:0xf bank_mask:0xf
    v_fmac_f32_dpp v34, v4, v26 row_newbcast:7 row_mask:0xf bank_mask:0xf
    v_fmac_f32_dpp v35, v4, v27 row_newbcast:7 row_mask:0xf bank_mask:0xf
    v_fmac_f32_dpp v36, v4, v28 row_newbcast:7 row_mask:0xf bank_mask:0xf
    v_fmac_f32_dpp v37, v4, v29 row_newbcast:7 row_mask:0xf bank_mask:0xf
    v_fmac_f32_dpp v38, v4, v30 row_newbcast:7 row_mask:0xf bank_mask:0xf
    v_fmac_f32_dpp v39, v4, v31 row_newbcast:7 row_mask:0xf bank_mask:0xf
    s_waitcnt vmcnt(11)
    v_lshlrev_b32 v24, 16, v160
    v_and_b32 v25, 0xffff0000, v160
    v_lshlrev_b32 v26, 16, v161
    v_and_b32 v27, 0xffff0000, v161
    v_lshlrev_b32 v28, 16, v162
    v_and_b32 v29, 0xffff0000, v162
    v_lshlrev_b32 v30, 16, v163
    v_and_b32 v31, 0xffff0000, v163
    v_fmac_f32_dpp v32, v4, v24 row_newbcast:8 row_mask:0xf bank_mask:0xf
    v_fmac_f32_dpp v33, v4, v25 row_newbcast:8 row_mask:0xf bank_mask:0xf
    v_fmac_f32_dpp v34, v4, v26 row_newbcast:8 row_mask:0xf bank_mask:0xf
    v_fmac_f32_dpp v35, v4, v27 row_newbcast:8 row_mask:0xf bank_mask:0xf
    v_fmac_f32_dpp v36, v4, v28 row_newbcast:8 row_mask:0xf bank_mask:0xf
    v_fmac_f32_dpp v37, v4, v29 row_newbcast:8 row_mask:0xf bank_mask:0xf
    v_fmac_f32_dpp v38, v4, v30 row_newbcast:8 row_mask:0xf bank_mask:0xf
    v_fmac_f32_dpp v39, v4, v31 row_newbcast:8 row_mask:0xf bank_mask:0xf
    s_waitcnt vmcnt(10)
    v_lshlrev_b32 v24, 16, v164
    v_and_b32 v25, 0xffff0000, v164
    v_lshlrev_b32 v26, 16, v165
    v_and_b32 v27, 0xffff0000, v165
    v_lshlrev_b32 v28, 16, v166
    v_and_b32 v29, 0xffff0000, v166
    v_lshlrev_b32 v30, 16, v167
    v_and_b32 v31, 0xffff0000, v167
    v_fmac_f32_dpp v32, v4, v24 row_newbcast:9 row_mask:0xf bank_mask:0xf
    v_fmac_f32_dpp v33, v4, v25 row_newbcast:9 row_mask:0xf bank_mask:0xf
    v_fmac_f32_dpp v34, v4, v26 row_newbcast:9 row_mask:0xf bank_mask:0xf
    v_fmac_f32_dpp v35, v4, v27 row_newbcast:9 row_mask:0xf bank_mask:0xf
    v_fmac_f32_dpp v36, v4, v28 row_newbcast:9 row_mask:0xf bank_mask:0xf
    v_fmac_f32_dpp v37, v4, v29 row_newbcast:9 row_mask:0xf bank_mask:0xf
    v_fmac_f32_dpp v38, v4, v30 row_newbcast:9 row_mask:0xf bank_mask:0xf
    v_fmac_f32_dpp v39, v4, v31 row_newbcast:9 row_mask:0xf bank_mask:0xf
    s_waitcnt vmcnt(9)
    v_lshlrev_b32 v24, 16, v168
    v_and_b32 v25, 0xffff0000, v168
    v_lshlrev_b32 v26, 16, v169
    v_and_b32 v27, 0xffff0000, v169
    v_lshlrev_b32 v28, 16, v170
    v_and_b32 v29, 0xffff0000, v170
    v_lshlrev_b32 v30, 16, v171
    v_and_b32 v31, 0xffff0000, v171
    v_fmac_f32_dpp v32, v4, v24 row_newbcast:10 row_mask:0xf bank_mask:0xf
    v_fmac_f32_dpp v33, v4, v25 row_newbcast:10 row_mask:0xf bank_mask:0xf
    v_fmac_f32_dpp v34, v4, v26 row_newbcast:10 row_mask:0xf bank_mask:0xf
    v_fmac_f32_dpp v35, v4, v27 row_newbcast:10 row_mask:0xf bank_mask:0xf
    v_fmac_f32_dpp v36, v4, v28 row_newbcast:10 row_mask:0xf bank_mask:0xf
    v_fmac_f32_dpp v37, v4, v29 row_newbcast:10 row_mask:0xf bank_mask:0xf
    v_fmac_f32_dpp v38, v4, v30 row_newbcast:10 row_mask:0xf bank_mask:0xf
    v_fmac_f32_dpp v39, v4, v31 row_newbcast:10 row_mask:0xf bank_mask:0xf
    s_waitcnt vmcnt(8)
    v_lshlrev_b32 v24, 16, v172
    v_and_b32 v25, 0xffff0000, v172
    v_lshlrev_b32 v26, 16, v173
    v_and_b32 v27, 0xffff0000, v173
    v_lshlrev_b32 v28, 16, v174
    v_and_b32 v29, 0xffff0000, v174
    v_lshlrev_b32 v30, 16, v175
    v_and_b32 v31, 0xffff0000, v175
    v_fmac_f32_dpp v32, v4, v24 row_newbcast:11 row_mask:0xf bank_mask:0xf
    v_fmac_f32_dpp v33, v4, v25 row_newbcast:11 row_mask:0xf bank_mask:0xf
    v_fmac_f32_dpp v34, v4, v26 row_newbcast:11 row_mask:0xf bank_mask:0xf
    v_fmac_f32_dpp v35, v4, v27 row_newbcast:11 row_mask:0xf bank_mask:0xf
    v_fmac_f32_dpp v36, v4, v28 row_newbcast:11 row_mask:0xf bank_mask:0xf
    v_fmac_f32_dpp v37, v4, v29 row_newbcast:11 row_mask:0xf bank_mask:0xf
    v_fmac_f32_dpp v38, v4, v30 row_newbcast:11 row_mask:0xf bank_mask:0xf
    v_fmac_f32_dpp v39, v4, v31 row_newbcast:11 row_mask:0xf bank_mask:0xf
    s_waitcnt vmcnt(7)
    v_lshlrev_b32 v24, 16, v176
    v_and_b32 v25, 0xffff0000, v176
    v_lshlrev_b32 v26, 16, v177
    v_and_b32 v27, 0xffff0000, v177
    v_lshlrev_b32 v28, 16, v178
    v_and_b32 v29, 0xffff0000, v178
    v_lshlrev_b32 v30, 16, v179
    v_and_b32 v31, 0xffff0000, v179
    v_fmac_f32_dpp v32, v4, v24 row_newbcast:12 row_mask:0xf bank_mask:0xf
    v_fmac_f32_dpp v33, v4, v25 row_newbcast:12 row_mask:0xf bank_mask:0xf
    v_fmac_f32_dpp v34, v4, v26 row_newbcast:12 row_mask:0xf bank_mask:0xf
    v_fmac_f32_dpp v35, v4, v27 row_newbcast:12 row_mask:0xf bank_mask:0xf
    v_fmac_f32_dpp v36, v4, v28 row_newbcast:12 row_mask:0xf bank_mask:0xf
    v_fmac_f32_dpp v37, v4, v29 row_newbcast:12 row_mask:0xf bank_mask:0xf
    v_fmac_f32_dpp v38, v4, v30 row_newbcast:12 row_mask:0xf bank_mask:0xf
    v_fmac_f32_dpp v39, v4, v31 row_newbcast:12 row_mask:0xf bank_mask:0xf
    s_waitcnt vmcnt(6)
    v_lshlrev_b32 v24, 16, v180
    v_and_b32 v25, 0xffff0000, v180
    v_lshlrev_b32 v26, 16, v181
    v_and_b32 v27, 0xffff0000, v181
    v_lshlrev_b32 v28, 16, v182
    v_and_b32 v29, 0xffff0000, v182
    v_lshlrev_b32 v30, 16, v183
    v_and_b32 v31, 0xffff0000, v183
    v_fmac_f32_dpp v32, v4, v24 row_newbcast:13 row_mask:0xf bank_mask:0xf
    v_fmac_f32_dpp v33, v4, v25 row_newbcast:13 row_mask:0xf bank_mask:0xf
    v_fmac_f32_dpp v34, v4, v26 row_newbcast:13 row_mask:0xf bank_mask:0xf
    v_fmac_f32_dpp v35, v4, v27 row_newbcast:13 row_mask:0xf bank_mask:0xf
    v_fmac_f32_dpp v36, v4, v28 row_newbcast:13 row_mask:0xf bank_mask:0xf
    v_fmac_f32_dpp v37, v4, v29 row_newbcast:13 row_mask:0xf bank_mask:0xf
    v_fmac_f32_dpp v38, v4, v30 row_newbcast:13 row_mask:0xf bank_mask:0xf
    v_fmac_f32_dpp v39, v4, v31 row_newbcast:13 row_mask:0xf bank_mask:0xf
    s_waitcnt vmcnt(5)
    v_lshlrev_b32 v24, 16, v184
    v_and_b32 v25, 0xffff0000, v184
    v_lshlrev_b32 v26, 16, v185
    v_and_b32 v27, 0xffff0000, v185
    v_lshlrev_b32 v28, 16, v186
    v_and_b32 v29, 0xffff0000, v186
    v_lshlrev_b32 v30, 16, v187
    v_and_b32 v31, 0xffff0000, v187
    v_fmac_f32_dpp v32, v4, v24 row_newbcast:14 row_mask:0xf bank_mask:0xf
    v_fmac_f32_dpp v33, v4, v25 row_newbcast:14 row_mask:0xf bank_mask:0xf
    v_fmac_f32_dpp v34, v4, v26 row_newbcast:14 row_mask:0xf bank_mask:0xf
    v_fmac_f32_dpp v35, v4, v27 row_newbcast:14 row_mask:0xf bank_mask:0xf
    v_fmac_f32_dpp v36, v4, v28 row_newbcast:14 row_mask:0xf bank_mask:0xf
    v_fmac_f32_dpp v37, v4, v29 row_newbcast:14 row_mask:0xf bank_mask:0xf
    v_fmac_f32_dpp v38, v4, v30 row_newbcast:14 row_mask:0xf bank_mask:0xf
    v_fmac_f32_dpp v39, v4, v31 row_newbcast:14 row_mask:0xf bank_mask:0xf
    s_waitcnt vmcnt(4)
    v_lshlrev_b32 v24, 16, v188
    v_and_b32 v25, 0xffff0000, v188
    v_lshlrev_b32 v26, 16, v189
    v_and_b32 v27, 0xffff0000, v189
    v_lshlrev_b32 v28, 16, v190
    v_and_b32 v29, 0xffff0000, v190
    v_lshlrev_b32 v30, 16, v191
    v_and_b32 v31, 0xffff0000, v191
    v_fmac_f32_dpp v32, v4, v24 row_newbcast:15 row_mask:0xf bank_mask:0xf
    v_fmac_f32_dpp v33, v4, v25 row_newbcast:15 row_mask:0xf bank_mask:0xf
    v_fmac_f32_dpp v34, v4, v26 row_newbcast:15 row_mask:0xf bank_mask:0xf
    v_fmac_f32_dpp v35, v4, v27 row_newbcast:15 row_mask:0xf bank_mask:0xf
    v_fmac_f32_dpp v36, v4, v28 row_newbcast:15 row_mask:0xf bank_mask:0xf
    v_fmac_f32_dpp v37, v4, v29 row_newbcast:15 row_mask:0xf bank_mask:0xf
    v_fmac_f32_dpp v38, v4, v30 row_newbcast:15 row_mask:0xf bank_mask:0xf
    v_fmac_f32_dpp v39, v4, v31 row_newbcast:15 row_mask:0xf bank_mask:0xf
    s_nop 1
    v_permlane32_swap_b32 v32, v36
    v_permlane32_swap_b32 v33, v37
    v_permlane32_swap_b32 v34, v38
    v_permlane32_swap_b32 v35, v39
    s_nop 1
    v_add_f32 v32, v32, v36
    v_add_f32 v33, v33, v37
    v_add_f32 v34, v34, v38
    v_add_f32 v35, v35, v39
    s_nop 1
    v_permlane16_swap_b32 v32, v34
    v_permlane16_swap_b32 v33, v35
    s_nop 1
    v_add_f32 v32, v32, v34
    v_add_f32 v33, v33, v35
    v_lshrrev_b32 v5, 4, v1
    v_and_b32 v6, 15, v1
    v_lshlrev_b32 v7, 3, v5
    v_lshl_add_u32 v7, v6, 5, v7
    s_lshl_b32 s67, s3, 9
    v_add_u32 v42, s67, v7
    ds_write_b64 v42, v[32:33] offset:0
    s_waitcnt lgkmcnt(0)
    s_barrier
    v_lshlrev_b32 v7, 5, v6
    ds_read_b128 v[128:131], v7 offset:0
    ds_read_b128 v[132:135], v7 offset:16
    ds_read_b128 v[136:139], v7 offset:512
    ds_read_b128 v[140:143], v7 offset:528
    ds_read_b128 v[144:147], v7 offset:1024
    ds_read_b128 v[148:151], v7 offset:1040
    ds_read_b128 v[152:155], v7 offset:1536
    ds_read_b128 v[156:159], v7 offset:1552
    ds_read_b128 v[160:163], v7 offset:2048
    ds_read_b128 v[164:167], v7 offset:2064
    ds_read_b128 v[168:171], v7 offset:2560
    ds_read_b128 v[172:175], v7 offset:2576
    ds_read_b128 v[176:179], v7 offset:3072
    ds_read_b128 v[180:183], v7 offset:3088
    ds_read_b128 v[184:187], v7 offset:3584
    ds_read_b128 v[188:191], v7 offset:3600
    s_waitcnt lgkmcnt(0)
    v_add_f32 v128, v128, v136
    v_add_f32 v129, v129, v137
    v_add_f32 v130, v130, v138
    v_add_f32 v131, v131, v139
    v_add_f32 v132, v132, v140
    v_add_f32 v133, v133, v141
    v_add_f32 v134, v134, v142
    v_add_f32 v135, v135, v143
    v_add_f32 v128, v128, v144
    v_add_f32 v129, v129, v145
    v_add_f32 v130, v130, v146
    v_add_f32 v131, v131, v147
    v_add_f32 v132, v132, v148
    v_add_f32 v133, v133, v149
    v_add_f32 v134, v134, v150
    v_add_f32 v135, v135, v151
    v_add_f32 v128, v128, v152
    v_add_f32 v129, v129, v153
    v_add_f32 v130, v130, v154
    v_add_f32 v131, v131, v155
    v_add_f32 v132, v132, v156
    v_add_f32 v133, v133, v157
    v_add_f32 v134, v134, v158
    v_add_f32 v135, v135, v159
    v_add_f32 v128, v128, v160
    v_add_f32 v129, v129, v161
    v_add_f32 v130, v130, v162
    v_add_f32 v131, v131, v163
    v_add_f32 v132, v132, v164
    v_add_f32 v133, v133, v165
    v_add_f32 v134, v134, v166
    v_add_f32 v135, v135, v167
    v_add_f32 v128, v128, v168
    v_add_f32 v129, v129, v169
    v_add_f32 v130, v130, v170
    v_add_f32 v131, v131, v171
    v_add_f32 v132, v132, v172
    v_add_f32 v133, v133, v173
    v_add_f32 v134, v134, v174
    v_add_f32 v135, v135, v175
    v_add_f32 v128, v128, v176
    v_add_f32 v129, v129, v177
    v_add_f32 v130, v130, v178
    v_add_f32 v131, v131, v179
    v_add_f32 v132, v132, v180
    v_add_f32 v133, v133, v181
    v_add_f32 v134, v134, v182
    v_add_f32 v135, v135, v183
    v_add_f32 v128, v128, v184
    v_add_f32 v129, v129, v185
    v_add_f32 v130, v130, v186
    v_add_f32 v131, v131, v187
    v_add_f32 v132, v132, v188
    v_add_f32 v133, v133, v189
    v_add_f32 v134, v134, v190
    v_add_f32 v135, v135, v191
    v_cvt_pk_bf16_f32 v8, v128, v129
    v_cvt_pk_bf16_f32 v9, v130, v131
    v_cvt_pk_bf16_f32 v10, v132, v133
    v_cvt_pk_bf16_f32 v11, v134, v135
    s_nop 1
    s_and_b32 s67, s20, 15
    s_lshl_b32 s67, s67, 15
    s_cmp_lt_u32 s20, 16
    s_cselect_b64 s[40:41], s[60:61], s[62:63]
    s_add_u32 s40, s40, s67
    s_addc_u32 s41, s41, 0
    s_cmp_lt_u32 s20, 32
    s_cselect_b32 s42, 4096, 0
    s_add_u32 s20, s20, 1
    s_waitcnt vmcnt(0)
    buffer_load_dwordx4 v[192:195], v2, s[48:51], 0 offen offset:0 nt
    buffer_load_dwordx4 v[196:199], v2, s[48:51], 0 offen offset:1024 nt
    buffer_load_dwordx4 v[200:203], v2, s[48:51], 0 offen offset:2048 nt
    buffer_load_dwordx4 v[204:207], v2, s[48:51], 0 offen offset:3072 nt
    buffer_load_dwordx4 v[80:83], v2, s[40:43], 0 offen offset:0 nt
    buffer_load_dwordx4 v[84:87], v2, s[40:43], 0 offen offset:1024 nt
    buffer_load_dwordx4 v[88:91], v2, s[40:43], 0 offen offset:2048 nt
    buffer_load_dwordx4 v[92:95], v2, s[40:43], 0 offen offset:3072 nt
    v_dot2_f32_bf16 v20, v64, v8, 0
    v_dot2_f32_bf16 v21, v68, v8, 0
    v_dot2_f32_bf16 v22, v72, v8, 0
    v_dot2_f32_bf16 v23, v76, v8, 0
    v_dot2_f32_bf16 v20, v65, v9, v20
    v_dot2_f32_bf16 v21, v69, v9, v21
    v_dot2_f32_bf16 v22, v73, v9, v22
    v_dot2_f32_bf16 v23, v77, v9, v23
    v_dot2_f32_bf16 v20, v66, v10, v20
    v_dot2_f32_bf16 v21, v70, v10, v21
    v_dot2_f32_bf16 v22, v74, v10, v22
    v_dot2_f32_bf16 v23, v78, v10, v23
    v_dot2_f32_bf16 v20, v67, v11, v20
    v_dot2_f32_bf16 v21, v71, v11, v21
    v_dot2_f32_bf16 v22, v75, v11, v22
    v_dot2_f32_bf16 v23, v79, v11, v23
    v_add_f32_dpp v20, v20, v20 row_ror:8 row_mask:0xf bank_mask:0xf
    v_add_f32_dpp v21, v21, v21 row_ror:8 row_mask:0xf bank_mask:0xf
    v_add_f32_dpp v22, v22, v22 row_ror:8 row_mask:0xf bank_mask:0xf
    v_add_f32_dpp v23, v23, v23 row_ror:8 row_mask:0xf bank_mask:0xf
    v_add_f32_dpp v20, v20, v20 row_ror:4 row_mask:0xf bank_mask:0xf
    v_add_f32_dpp v21, v21, v21 row_ror:4 row_mask:0xf bank_mask:0xf
    v_add_f32_dpp v22, v22, v22 row_ror:4 row_mask:0xf bank_mask:0xf
    v_add_f32_dpp v23, v23, v23 row_ror:4 row_mask:0xf bank_mask:0xf
    v_add_f32_dpp v20, v20, v20 row_ror:2 row_mask:0xf bank_mask:0xf
    v_add_f32_dpp v21, v21, v21 row_ror:2 row_mask:0xf bank_mask:0xf
    v_add_f32_dpp v22, v22, v22 row_ror:2 row_mask:0xf bank_mask:0xf
    v_add_f32_dpp v23, v23, v23 row_ror:2 row_mask:0xf bank_mask:0xf
    v_add_f32_dpp v20, v20, v20 row_ror:1 row_mask:0xf bank_mask:0xf
    v_add_f32_dpp v21, v21, v21 row_ror:1 row_mask:0xf bank_mask:0xf
    v_add_f32_dpp v22, v22, v22 row_ror:1 row_mask:0xf bank_mask:0xf
    v_add_f32_dpp v23, v23, v23 row_ror:1 row_mask:0xf bank_mask:0xf
    v_cndmask_b32 v16, v16, v20, s[70:71]
    v_cndmask_b32 v16, v16, v21, s[72:73]
    v_cndmask_b32 v16, v16, v22, s[74:75]
    v_cndmask_b32 v16, v16, v23, s[76:77]
    s_and_b32 s67, s20, 15
    s_lshl_b32 s67, s67, 15
    s_cmp_lt_u32 s20, 16
    s_cselect_b64 s[40:41], s[60:61], s[62:63]
    s_add_u32 s40, s40, s67
    s_addc_u32 s41, s41, 0
    s_cmp_lt_u32 s20, 32
    s_cselect_b32 s42, 4096, 0
    s_add_u32 s20, s20, 1
    s_waitcnt vmcnt(0)
    buffer_load_dwordx4 v[208:211], v2, s[48:51], s64 offen offset:0 nt
    buffer_load_dwordx4 v[212:215], v2, s[48:51], s64 offen offset:1024 nt
    buffer_load_dwordx4 v[216:219], v2, s[48:51], s64 offen offset:2048 nt
    buffer_load_dwordx4 v[220:223], v2, s[48:51], s64 offen offset:3072 nt
    buffer_load_dwordx4 v[64:67], v2, s[40:43], 0 offen offset:0 nt
    buffer_load_dwordx4 v[68:71], v2, s[40:43], 0 offen offset:1024 nt
    buffer_load_dwordx4 v[72:75], v2, s[40:43], 0 offen offset:2048 nt
    buffer_load_dwordx4 v[76:79], v2, s[40:43], 0 offen offset:3072 nt
    v_dot2_f32_bf16 v20, v80, v8, 0
    v_dot2_f32_bf16 v21, v84, v8, 0
    v_dot2_f32_bf16 v22, v88, v8, 0
    v_dot2_f32_bf16 v23, v92, v8, 0
    v_dot2_f32_bf16 v20, v81, v9, v20
    v_dot2_f32_bf16 v21, v85, v9, v21
    v_dot2_f32_bf16 v22, v89, v9, v22
    v_dot2_f32_bf16 v23, v93, v9, v23
    v_dot2_f32_bf16 v20, v82, v10, v20
    v_dot2_f32_bf16 v21, v86, v10, v21
    v_dot2_f32_bf16 v22, v90, v10, v22
    v_dot2_f32_bf16 v23, v94, v10, v23
    v_dot2_f32_bf16 v20, v83, v11, v20
    v_dot2_f32_bf16 v21, v87, v11, v21
    v_dot2_f32_bf16 v22, v91, v11, v22
    v_dot2_f32_bf16 v23, v95, v11, v23
    v_add_f32_dpp v20, v20, v20 row_ror:8 row_mask:0xf bank_mask:0xf
    v_add_f32_dpp v21, v21, v21 row_ror:8 row_mask:0xf bank_mask:0xf
    v_add_f32_dpp v22, v22, v22 row_ror:8 row_mask:0xf bank_mask:0xf
    v_add_f32_dpp v23, v23, v23 row_ror:8 row_mask:0xf bank_mask:0xf
    v_add_f32_dpp v20, v20, v20 row_ror:4 row_mask:0xf bank_mask:0xf
    v_add_f32_dpp v21, v21, v21 row_ror:4 row_mask:0xf bank_mask:0xf
    v_add_f32_dpp v22, v22, v22 row_ror:4 row_mask:0xf bank_mask:0xf
    v_add_f32_dpp v23, v23, v23 row_ror:4 row_mask:0xf bank_mask:0xf
    v_add_f32_dpp v20, v20, v20 row_ror:2 row_mask:0xf bank_mask:0xf
    v_add_f32_dpp v21, v21, v21 row_ror:2 row_mask:0xf bank_mask:0xf
    v_add_f32_dpp v22, v22, v22 row_ror:2 row_mask:0xf bank_mask:0xf
    v_add_f32_dpp v23, v23, v23 row_ror:2 row_mask:0xf bank_mask:0xf
    v_add_f32_dpp v20, v20, v20 row_ror:1 row_mask:0xf bank_mask:0xf
    v_add_f32_dpp v21, v21, v21 row_ror:1 row_mask:0xf bank_mask:0xf
    v_add_f32_dpp v22, v22, v22 row_ror:1 row_mask:0xf bank_mask:0xf
    v_add_f32_dpp v23, v23, v23 row_ror:1 row_mask:0xf bank_mask:0xf
    v_cndmask_b32 v16, v16, v20, s[78:79]
    v_cndmask_b32 v16, v16, v21, s[80:81]
    v_cndmask_b32 v16, v16, v22, s[82:83]
    v_cndmask_b32 v16, v16, v23, s[84:85]
    s_and_b32 s67, s20, 15
    s_lshl_b32 s67, s67, 15
    s_cmp_lt_u32 s20, 16
    s_cselect_b64 s[40:41], s[60:61], s[62:63]
    s_add_u32 s40, s40, s67
    s_addc_u32 s41, s41, 0
    s_cmp_lt_u32 s20, 32
    s_cselect_b32 s42, 4096, 0
    s_add_u32 s20, s20, 1
    s_waitcnt vmcnt(0)
    buffer_load_dwordx4 v[224:227], v2, s[48:51], s21 offen offset:0 nt
    buffer_load_dwordx4 v[228:231], v2, s[48:51], s21 offen offset:1024 nt
    buffer_load_dwordx4 v[232:235], v2, s[48:51], s21 offen offset:2048 nt
    buffer_load_dwordx4 v[236:239], v2, s[48:51], s21 offen offset:3072 nt
    buffer_load_dwordx4 v[80:83], v2, s[40:43], 0 offen offset:0 nt
    buffer_load_dwordx4 v[84:87], v2, s[40:43], 0 offen offset:1024 nt
    buffer_load_dwordx4 v[88:91], v2, s[40:43], 0 offen offset:2048 nt
    buffer_load_dwordx4 v[92:95], v2, s[40:43], 0 offen offset:3072 nt
    v_dot2_f32_bf16 v20, v64, v8, 0
    v_dot2_f32_bf16 v21, v68, v8, 0
    v_dot2_f32_bf16 v22, v72, v8, 0
    v_dot2_f32_bf16 v23, v76, v8, 0
    v_dot2_f32_bf16 v20, v65, v9, v20
    v_dot2_f32_bf16 v21, v69, v9, v21
    v_dot2_f32_bf16 v22, v73, v9, v22
    v_dot2_f32_bf16 v23, v77, v9, v23
    v_dot2_f32_bf16 v20, v66, v10, v20
    v_dot2_f32_bf16 v21, v70, v10, v21
    v_dot2_f32_bf16 v22, v74, v10, v22
    v_dot2_f32_bf16 v23, v78, v10, v23
    v_dot2_f32_bf16 v20, v67, v11, v20
    v_dot2_f32_bf16 v21, v71, v11, v21
    v_dot2_f32_bf16 v22, v75, v11, v22
    v_dot2_f32_bf16 v23, v79, v11, v23
    v_add_f32_dpp v20, v20, v20 row_ror:8 row_mask:0xf bank_mask:0xf
    v_add_f32_dpp v21, v21, v21 row_ror:8 row_mask:0xf bank_mask:0xf
    v_add_f32_dpp v22, v22, v22 row_ror:8 row_mask:0xf bank_mask:0xf
    v_add_f32_dpp v23, v23, v23 row_ror:8 row_mask:0xf bank_mask:0xf
    v_add_f32_dpp v20, v20, v20 row_ror:4 row_mask:0xf bank_mask:0xf
    v_add_f32_dpp v21, v21, v21 row_ror:4 row_mask:0xf bank_mask:0xf
    v_add_f32_dpp v22, v22, v22 row_ror:4 row_mask:0xf bank_mask:0xf
    v_add_f32_dpp v23, v23, v23 row_ror:4 row_mask:0xf bank_mask:0xf
    v_add_f32_dpp v20, v20, v20 row_ror:2 row_mask:0xf bank_mask:0xf
    v_add_f32_dpp v21, v21, v21 row_ror:2 row_mask:0xf bank_mask:0xf
    v_add_f32_dpp v22, v22, v22 row_ror:2 row_mask:0xf bank_mask:0xf
    v_add_f32_dpp v23, v23, v23 row_ror:2 row_mask:0xf bank_mask:0xf
    v_add_f32_dpp v20, v20, v20 row_ror:1 row_mask:0xf bank_mask:0xf
    v_add_f32_dpp v21, v21, v21 row_ror:1 row_mask:0xf bank_mask:0xf
    v_add_f32_dpp v22, v22, v22 row_ror:1 row_mask:0xf bank_mask:0xf
    v_add_f32_dpp v23, v23, v23 row_ror:1 row_mask:0xf bank_mask:0xf
    v_cndmask_b32 v16, v16, v20, s[86:87]
    v_cndmask_b32 v16, v16, v21, s[88:89]
    v_cndmask_b32 v16, v16, v22, s[90:91]
    v_cndmask_b32 v16, v16, v23, s[92:93]
    s_and_b32 s67, s20, 15
    s_lshl_b32 s67, s67, 15
    s_cmp_lt_u32 s20, 16
    s_cselect_b64 s[40:41], s[60:61], s[62:63]
    s_add_u32 s40, s40, s67
    s_addc_u32 s41, s41, 0
    s_cmp_lt_u32 s20, 32
    s_cselect_b32 s42, 4096, 0
    s_add_u32 s20, s20, 1
    s_waitcnt vmcnt(0)
    buffer_load_dwordx4 v[240:243], v2, s[48:51], s22 offen offset:0 nt
    buffer_load_dwordx4 v[244:247], v2, s[48:51], s22 offen offset:1024 nt
    buffer_load_dwordx4 v[248:251], v2, s[48:51], s22 offen offset:2048 nt
    buffer_load_dwordx4 v[252:255], v2, s[48:51], s22 offen offset:3072 nt
    buffer_load_dwordx4 v[64:67], v2, s[40:43], 0 offen offset:0 nt
    buffer_load_dwordx4 v[68:71], v2, s[40:43], 0 offen offset:1024 nt
    buffer_load_dwordx4 v[72:75], v2, s[40:43], 0 offen offset:2048 nt
    buffer_load_dwordx4 v[76:79], v2, s[40:43], 0 offen offset:3072 nt
    v_dot2_f32_bf16 v20, v80, v8, 0
    v_dot2_f32_bf16 v21, v84, v8, 0
    v_dot2_f32_bf16 v22, v88, v8, 0
    v_dot2_f32_bf16 v23, v92, v8, 0
    v_dot2_f32_bf16 v20, v81, v9, v20
    v_dot2_f32_bf16 v21, v85, v9, v21
    v_dot2_f32_bf16 v22, v89, v9, v22
    v_dot2_f32_bf16 v23, v93, v9, v23
    v_dot2_f32_bf16 v20, v82, v10, v20
    v_dot2_f32_bf16 v21, v86, v10, v21
    v_dot2_f32_bf16 v22, v90, v10, v22
    v_dot2_f32_bf16 v23, v94, v10, v23
    v_dot2_f32_bf16 v20, v83, v11, v20
    v_dot2_f32_bf16 v21, v87, v11, v21
    v_dot2_f32_bf16 v22, v91, v11, v22
    v_dot2_f32_bf16 v23, v95, v11, v23
    v_add_f32_dpp v20, v20, v20 row_ror:8 row_mask:0xf bank_mask:0xf
    v_add_f32_dpp v21, v21, v21 row_ror:8 row_mask:0xf bank_mask:0xf
    v_add_f32_dpp v22, v22, v22 row_ror:8 row_mask:0xf bank_mask:0xf
    v_add_f32_dpp v23, v23, v23 row_ror:8 row_mask:0xf bank_mask:0xf
    v_add_f32_dpp v20, v20, v20 row_ror:4 row_mask:0xf bank_mask:0xf
    v_add_f32_dpp v21, v21, v21 row_ror:4 row_mask:0xf bank_mask:0xf
    v_add_f32_dpp v22, v22, v22 row_ror:4 row_mask:0xf bank_mask:0xf
    v_add_f32_dpp v23, v23, v23 row_ror:4 row_mask:0xf bank_mask:0xf
    v_add_f32_dpp v20, v20, v20 row_ror:2 row_mask:0xf bank_mask:0xf
    v_add_f32_dpp v21, v21, v21 row_ror:2 row_mask:0xf bank_mask:0xf
    v_add_f32_dpp v22, v22, v22 row_ror:2 row_mask:0xf bank_mask:0xf
    v_add_f32_dpp v23, v23, v23 row_ror:2 row_mask:0xf bank_mask:0xf
    v_add_f32_dpp v20, v20, v20 row_ror:1 row_mask:0xf bank_mask:0xf
    v_add_f32_dpp v21, v21, v21 row_ror:1 row_mask:0xf bank_mask:0xf
    v_add_f32_dpp v22, v22, v22 row_ror:1 row_mask:0xf bank_mask:0xf
    v_add_f32_dpp v23, v23, v23 row_ror:1 row_mask:0xf bank_mask:0xf
    v_cndmask_b32 v16, v16, v20, s[94:95]
    v_cndmask_b32 v16, v16, v21, s[96:97]
    v_cndmask_b32 v16, v16, v22, s[98:99]
    v_cndmask_b32 v16, v16, v23, s[100:101]
    v_mov_b32 v12, v13
    v_mov_b32 v13, v14
    v_mov_b32 v14, v15
    v_cvt_pk_bf16_f32 v24, v16, v16
    v_lshlrev_b32 v24, 16, v24
    v_mul_f32 v24, s66, v24
    v_cvt_pk_bf16_f32 v24, v24, v24
    v_lshlrev_b32 v15, 16, v24
    s_mov_b32 s69, 0
L_kloop:
    s_and_b32 s67, s20, 15
    s_lshl_b32 s67, s67, 15
    s_cmp_lt_u32 s20, 16
    s_cselect_b64 s[40:41], s[60:61], s[62:63]
    s_add_u32 s40, s40, s67
    s_addc_u32 s41, s41, 0
    s_cmp_lt_u32 s20, 32
    s_cselect_b32 s42, 4096, 0
    s_add_u32 s20, s20, 1
    s_waitcnt vmcnt(0)
    buffer_load_dwordx4 v[80:83], v2, s[40:43], 0 offen offset:0 nt
    buffer_load_dwordx4 v[84:87], v2, s[40:43], 0 offen offset:1024 nt
    buffer_load_dwordx4 v[88:91], v2, s[40:43], 0 offen offset:2048 nt
    buffer_load_dwordx4 v[92:95], v2, s[40:43], 0 offen offset:3072 nt
    v_dot2_f32_bf16 v20, v64, v8, 0
    v_dot2_f32_bf16 v21, v68, v8, 0
    v_dot2_f32_bf16 v22, v72, v8, 0
    v_dot2_f32_bf16 v23, v76, v8, 0
    v_dot2_f32_bf16 v20, v65, v9, v20
    v_dot2_f32_bf16 v21, v69, v9, v21
    v_dot2_f32_bf16 v22, v73, v9, v22
    v_dot2_f32_bf16 v23, v77, v9, v23
    v_dot2_f32_bf16 v20, v66, v10, v20
    v_dot2_f32_bf16 v21, v70, v10, v21
    v_dot2_f32_bf16 v22, v74, v10, v22
    v_dot2_f32_bf16 v23, v78, v10, v23
    v_dot2_f32_bf16 v20, v67, v11, v20
    v_dot2_f32_bf16 v21, v71, v11, v21
    v_dot2_f32_bf16 v22, v75, v11, v22
    v_dot2_f32_bf16 v23, v79, v11, v23
    v_add_f32_dpp v20, v20, v20 row_ror:8 row_mask:0xf bank_mask:0xf
    v_add_f32_dpp v21, v21, v21 row_ror:8 row_mask:0xf bank_mask:0xf
    v_add_f32_dpp v22, v22, v22 row_ror:8 row_mask:0xf bank_mask:0xf
    v_add_f32_dpp v23, v23, v23 row_ror:8 row_mask:0xf bank_mask:0xf
    v_add_f32_dpp v20, v20, v20 row_ror:4 row_mask:0xf bank_mask:0xf
    v_add_f32_dpp v21, v21, v21 row_ror:4 row_mask:0xf bank_mask:0xf
    v_add_f32_dpp v22, v22, v22 row_ror:4 row_mask:0xf bank_mask:0xf
    v_add_f32_dpp v23, v23, v23 row_ror:4 row_mask:0xf bank_mask:0xf
    v_add_f32_dpp v20, v20, v20 row_ror:2 row_mask:0xf bank_mask:0xf
    v_add_f32_dpp v21, v21, v21 row_ror:2 row_mask:0xf bank_mask:0xf
    v_add_f32_dpp v22, v22, v22 row_ror:2 row_mask:0xf bank_mask:0xf
    v_add_f32_dpp v23, v23, v23 row_ror:2 row_mask:0xf bank_mask:0xf
    v_add_f32_dpp v20, v20, v20 row_ror:1 row_mask:0xf bank_mask:0xf
    v_add_f32_dpp v21, v21, v21 row_ror:1 row_mask:0xf bank_mask:0xf
    v_add_f32_dpp v22, v22, v22 row_ror:1 row_mask:0xf bank_mask:0xf
    v_add_f32_dpp v23, v23, v23 row_ror:1 row_mask:0xf bank_mask:0xf
    v_cndmask_b32 v16, v16, v20, s[70:71]
    v_cndmask_b32 v16, v16, v21, s[72:73]
    v_cndmask_b32 v16, v16, v22, s[74:75]
    v_cndmask_b32 v16, v16, v23, s[76:77]
    s_and_b32 s67, s20, 15
    s_lshl_b32 s67, s67, 15
    s_cmp_lt_u32 s20, 16
    s_cselect_b64 s[40:41], s[60:61], s[62:63]
    s_add_u32 s40, s40, s67
    s_addc_u32 s41, s41, 0
    s_cmp_lt_u32 s20, 32
    s_cselect_b32 s42, 4096, 0
    s_add_u32 s20, s20, 1
    s_waitcnt vmcnt(0)
    buffer_load_dwordx4 v[64:67], v2, s[40:43], 0 offen offset:0 nt
    buffer_load_dwordx4 v[68:71], v2, s[40:43], 0 offen offset:1024 nt
    buffer_load_dwordx4 v[72:75], v2, s[40:43], 0 offen offset:2048 nt
    buffer_load_dwordx4 v[76:79], v2, s[40:43], 0 offen offset:3072 nt
    v_dot2_f32_bf16 v20, v80, v8, 0
    v_dot2_f32_bf16 v21, v84, v8, 0
    v_dot2_f32_bf16 v22, v88, v8, 0
    v_dot2_f32_bf16 v23, v92, v8, 0
    v_dot2_f32_bf16 v20, v81, v9, v20
    v_dot2_f32_bf16 v21, v85, v9, v21
    v_dot2_f32_bf16 v22, v89, v9, v22
    v_dot2_f32_bf16 v23, v93, v9, v23
    v_dot2_f32_bf16 v20, v82, v10, v20
    v_dot2_f32_bf16 v21, v86, v10, v21
    v_dot2_f32_bf16 v22, v90, v10, v22
    v_dot2_f32_bf16 v23, v94, v10, v23
    v_dot2_f32_bf16 v20, v83, v11, v20
    v_dot2_f32_bf16 v21, v87, v11, v21
    v_dot2_f32_bf16 v22, v91, v11, v22
    v_dot2_f32_bf16 v23, v95, v11, v23
    v_add_f32_dpp v20, v20, v20 row_ror:8 row_mask:0xf bank_mask:0xf
    v_add_f32_dpp v21, v21, v21 row_ror:8 row_mask:0xf bank_mask:0xf
    v_add_f32_dpp v22, v22, v22 row_ror:8 row_mask:0xf bank_mask:0xf
    v_add_f32_dpp v23, v23, v23 row_ror:8 row_mask:0xf bank_mask:0xf
    v_add_f32_dpp v20, v20, v20 row_ror:4 row_mask:0xf bank_mask:0xf
    v_add_f32_dpp v21, v21, v21 row_ror:4 row_mask:0xf bank_mask:0xf
    v_add_f32_dpp v22, v22, v22 row_ror:4 row_mask:0xf bank_mask:0xf
    v_add_f32_dpp v23, v23, v23 row_ror:4 row_mask:0xf bank_mask:0xf
    v_add_f32_dpp v20, v20, v20 row_ror:2 row_mask:0xf bank_mask:0xf
    v_add_f32_dpp v21, v21, v21 row_ror:2 row_mask:0xf bank_mask:0xf
    v_add_f32_dpp v22, v22, v22 row_ror:2 row_mask:0xf bank_mask:0xf
    v_add_f32_dpp v23, v23, v23 row_ror:2 row_mask:0xf bank_mask:0xf
    v_add_f32_dpp v20, v20, v20 row_ror:1 row_mask:0xf bank_mask:0xf
    v_add_f32_dpp v21, v21, v21 row_ror:1 row_mask:0xf bank_mask:0xf
    v_add_f32_dpp v22, v22, v22 row_ror:1 row_mask:0xf bank_mask:0xf
    v_add_f32_dpp v23, v23, v23 row_ror:1 row_mask:0xf bank_mask:0xf
    v_cndmask_b32 v16, v16, v20, s[78:79]
    v_cndmask_b32 v16, v16, v21, s[80:81]
    v_cndmask_b32 v16, v16, v22, s[82:83]
    v_cndmask_b32 v16, v16, v23, s[84:85]
    s_and_b32 s67, s20, 15
    s_lshl_b32 s67, s67, 15
    s_cmp_lt_u32 s20, 16
    s_cselect_b64 s[40:41], s[60:61], s[62:63]
    s_add_u32 s40, s40, s67
    s_addc_u32 s41, s41, 0
    s_cmp_lt_u32 s20, 32
    s_cselect_b32 s42, 4096, 0
    s_add_u32 s20, s20, 1
    s_waitcnt vmcnt(0)
    buffer_load_dwordx4 v[80:83], v2, s[40:43], 0 offen offset:0 nt
    buffer_load_dwordx4 v[84:87], v2, s[40:43], 0 offen offset:1024 nt
    buffer_load_dwordx4 v[88:91], v2, s[40:43], 0 offen offset:2048 nt
    buffer_load_dwordx4 v[92:95], v2, s[40:43], 0 offen offset:3072 nt
    v_dot2_f32_bf16 v20, v64, v8, 0
    v_dot2_f32_bf16 v21, v68, v8, 0
    v_dot2_f32_bf16 v22, v72, v8, 0
    v_dot2_f32_bf16 v23, v76, v8, 0
    v_dot2_f32_bf16 v20, v65, v9, v20
    v_dot2_f32_bf16 v21, v69, v9, v21
    v_dot2_f32_bf16 v22, v73, v9, v22
    v_dot2_f32_bf16 v23, v77, v9, v23
    v_dot2_f32_bf16 v20, v66, v10, v20
    v_dot2_f32_bf16 v21, v70, v10, v21
    v_dot2_f32_bf16 v22, v74, v10, v22
    v_dot2_f32_bf16 v23, v78, v10, v23
    v_dot2_f32_bf16 v20, v67, v11, v20
    v_dot2_f32_bf16 v21, v71, v11, v21
    v_dot2_f32_bf16 v22, v75, v11, v22
    v_dot2_f32_bf16 v23, v79, v11, v23
    v_add_f32_dpp v20, v20, v20 row_ror:8 row_mask:0xf bank_mask:0xf
    v_add_f32_dpp v21, v21, v21 row_ror:8 row_mask:0xf bank_mask:0xf
    v_add_f32_dpp v22, v22, v22 row_ror:8 row_mask:0xf bank_mask:0xf
    v_add_f32_dpp v23, v23, v23 row_ror:8 row_mask:0xf bank_mask:0xf
    v_add_f32_dpp v20, v20, v20 row_ror:4 row_mask:0xf bank_mask:0xf
    v_add_f32_dpp v21, v21, v21 row_ror:4 row_mask:0xf bank_mask:0xf
    v_add_f32_dpp v22, v22, v22 row_ror:4 row_mask:0xf bank_mask:0xf
    v_add_f32_dpp v23, v23, v23 row_ror:4 row_mask:0xf bank_mask:0xf
    v_add_f32_dpp v20, v20, v20 row_ror:2 row_mask:0xf bank_mask:0xf
    v_add_f32_dpp v21, v21, v21 row_ror:2 row_mask:0xf bank_mask:0xf
    v_add_f32_dpp v22, v22, v22 row_ror:2 row_mask:0xf bank_mask:0xf
    v_add_f32_dpp v23, v23, v23 row_ror:2 row_mask:0xf bank_mask:0xf
    v_add_f32_dpp v20, v20, v20 row_ror:1 row_mask:0xf bank_mask:0xf
    v_add_f32_dpp v21, v21, v21 row_ror:1 row_mask:0xf bank_mask:0xf
    v_add_f32_dpp v22, v22, v22 row_ror:1 row_mask:0xf bank_mask:0xf
    v_add_f32_dpp v23, v23, v23 row_ror:1 row_mask:0xf bank_mask:0xf
    v_cndmask_b32 v16, v16, v20, s[86:87]
    v_cndmask_b32 v16, v16, v21, s[88:89]
    v_cndmask_b32 v16, v16, v22, s[90:91]
    v_cndmask_b32 v16, v16, v23, s[92:93]
    s_and_b32 s67, s20, 15
    s_lshl_b32 s67, s67, 15
    s_cmp_lt_u32 s20, 16
    s_cselect_b64 s[40:41], s[60:61], s[62:63]
    s_add_u32 s40, s40, s67
    s_addc_u32 s41, s41, 0
    s_cmp_lt_u32 s20, 32
    s_cselect_b32 s42, 4096, 0
    s_add_u32 s20, s20, 1
    s_waitcnt vmcnt(0)
    buffer_load_dwordx4 v[64:67], v2, s[40:43], 0 offen offset:0 nt
    buffer_load_dwordx4 v[68:71], v2, s[40:43], 0 offen offset:1024 nt
    buffer_load_dwordx4 v[72:75], v2, s[40:43], 0 offen offset:2048 nt
    buffer_load_dwordx4 v[76:79], v2, s[40:43], 0 offen offset:3072 nt
    v_dot2_f32_bf16 v20, v80, v8, 0
    v_dot2_f32_bf16 v21, v84, v8, 0
    v_dot2_f32_bf16 v22, v88, v8, 0
    v_dot2_f32_bf16 v23, v92, v8, 0
    v_dot2_f32_bf16 v20, v81, v9, v20
    v_dot2_f32_bf16 v21, v85, v9, v21
    v_dot2_f32_bf16 v22, v89, v9, v22
    v_dot2_f32_bf16 v23, v93, v9, v23
    v_dot2_f32_bf16 v20, v82, v10, v20
    v_dot2_f32_bf16 v21, v86, v10, v21
    v_dot2_f32_bf16 v22, v90, v10, v22
    v_dot2_f32_bf16 v23, v94, v10, v23
    v_dot2_f32_bf16 v20, v83, v11, v20
    v_dot2_f32_bf16 v21, v87, v11, v21
    v_dot2_f32_bf16 v22, v91, v11, v22
    v_dot2_f32_bf16 v23, v95, v11, v23
    v_add_f32_dpp v20, v20, v20 row_ror:8 row_mask:0xf bank_mask:0xf
    v_add_f32_dpp v21, v21, v21 row_ror:8 row_mask:0xf bank_mask:0xf
    v_add_f32_dpp v22, v22, v22 row_ror:8 row_mask:0xf bank_mask:0xf
    v_add_f32_dpp v23, v23, v23 row_ror:8 row_mask:0xf bank_mask:0xf
    v_add_f32_dpp v20, v20, v20 row_ror:4 row_mask:0xf bank_mask:0xf
    v_add_f32_dpp v21, v21, v21 row_ror:4 row_mask:0xf bank_mask:0xf
    v_add_f32_dpp v22, v22, v22 row_ror:4 row_mask:0xf bank_mask:0xf
    v_add_f32_dpp v23, v23, v23 row_ror:4 row_mask:0xf bank_mask:0xf
    v_add_f32_dpp v20, v20, v20 row_ror:2 row_mask:0xf bank_mask:0xf
    v_add_f32_dpp v21, v21, v21 row_ror:2 row_mask:0xf bank_mask:0xf
    v_add_f32_dpp v22, v22, v22 row_ror:2 row_mask:0xf bank_mask:0xf
    v_add_f32_dpp v23, v23, v23 row_ror:2 row_mask:0xf bank_mask:0xf
    v_add_f32_dpp v20, v20, v20 row_ror:1 row_mask:0xf bank_mask:0xf
    v_add_f32_dpp v21, v21, v21 row_ror:1 row_mask:0xf bank_mask:0xf
    v_add_f32_dpp v22, v22, v22 row_ror:1 row_mask:0xf bank_mask:0xf
    v_add_f32_dpp v23, v23, v23 row_ror:1 row_mask:0xf bank_mask:0xf
    v_cndmask_b32 v16, v16, v20, s[94:95]
    v_cndmask_b32 v16, v16, v21, s[96:97]
    v_cndmask_b32 v16, v16, v22, s[98:99]
    v_cndmask_b32 v16, v16, v23, s[100:101]
    v_mov_b32 v12, v13
    v_mov_b32 v13, v14
    v_mov_b32 v14, v15
    v_cvt_pk_bf16_f32 v24, v16, v16
    v_lshlrev_b32 v24, 16, v24
    v_mul_f32 v24, s66, v24
    v_cvt_pk_bf16_f32 v24, v24, v24
    v_lshlrev_b32 v15, 16, v24
    s_add_u32 s69, s69, 1
    s_cmp_lt_u32 s69, 3
    s_cbranch_scc1 L_kloop
    v_max_f32 v40, v12, v13
    v_max3_f32 v40, v40, v14, v15
    s_nop 1
    v_max_f32_dpp v40, v40, v40 row_ror:8 row_mask:0xf bank_mask:0xf
    s_nop 1
    v_max_f32_dpp v40, v40, v40 row_ror:4 row_mask:0xf bank_mask:0xf
    s_nop 1
    v_max_f32_dpp v40, v40, v40 row_ror:2 row_mask:0xf bank_mask:0xf
    s_nop 1
    v_max_f32_dpp v40, v40, v40 row_ror:1 row_mask:0xf bank_mask:0xf
    s_nop 1
    v_readlane_b32 s16, v40, 0
    v_readlane_b32 s17, v40, 16
    v_readlane_b32 s18, v40, 32
    v_readlane_b32 s19, v40, 48
    s_nop 1
    v_mov_b32 v40, s16
    v_max_f32 v40, s17, v40
    v_max_f32 v40, s18, v40
    v_max_f32 v40, s19, v40
    v_sub_f32 v12, v12, v40
    v_sub_f32 v13, v13, v40
    v_sub_f32 v14, v14, v40
    v_sub_f32 v15, v15, v40
    v_mul_f32 v12, s65, v12
    v_mul_f32 v13, s65, v13
    v_mul_f32 v14, s65, v14
    v_mul_f32 v15, s65, v15
    v_exp_f32 v12, v12
    v_exp_f32 v13, v13
    v_exp_f32 v14, v14
    v_exp_f32 v15, v15
    s_nop 0
    v_add_f32 v41, v12, v13
    v_add_f32 v41, v41, v14
    v_add_f32 v41, v41, v15
    s_nop 1
    v_add_f32_dpp v41, v41, v41 row_ror:8 row_mask:0xf bank_mask:0xf
    s_nop 1
    v_add_f32_dpp v41, v41, v41 row_ror:4 row_mask:0xf bank_mask:0xf
    s_nop 1
    v_add_f32_dpp v41, v41, v41 row_ror:2 row_mask:0xf bank_mask:0xf
    s_nop 1
    v_add_f32_dpp v41, v41, v41 row_ror:1 row_mask:0xf bank_mask:0xf
    s_nop 1
    v_readlane_b32 s16, v41, 0
    v_readlane_b32 s17, v41, 16
    v_readlane_b32 s18, v41, 32
    v_readlane_b32 s19, v41, 48
    s_nop 1
    v_mov_b32 v41, s16
    v_add_f32 v41, s17, v41
    v_add_f32 v41, s18, v41
    v_add_f32 v41, s19, v41
    s_lshl_b32 s67, s3, 3
    v_mov_b32 v5, s67
    s_mov_b64 exec, 1
    ds_write_b64 v5, v[40:41] offset:8192
    s_mov_b64 exec, -1
    v_mov_b32 v32, 0
    v_mov_b32 v33, 0
    v_mov_b32 v34, 0
    v_mov_b32 v35, 0
    v_mov_b32 v36, 0
    v_mov_b32 v37, 0
    v_mov_b32 v38, 0
    v_mov_b32 v39, 0
    s_waitcnt vmcnt(4)
    v_lshlrev_b32 v112, 16, v192
    v_and_b32 v113, 0xffff0000, v192
    v_lshlrev_b32 v114, 16, v193
    v_and_b32 v115, 0xffff0000, v193
    v_lshlrev_b32 v116, 16, v194
    v_and_b32 v117, 0xffff0000, v194
    v_lshlrev_b32 v118, 16, v195
    v_and_b32 v119, 0xffff0000, v195
    v_lshlrev_b32 v120, 16, v196
    v_and_b32 v121, 0xffff0000, v196
    v_lshlrev_b32 v122, 16, v197
    v_and_b32 v123, 0xffff0000, v197
    v_lshlrev_b32 v124, 16, v198
    v_and_b32 v125, 0xffff0000, v198
    v_lshlrev_b32 v126, 16, v199
    v_and_b32 v127, 0xffff0000, v199
    v_lshlrev_b32 v128, 16, v200
    v_and_b32 v129, 0xffff0000, v200
    v_lshlrev_b32 v130, 16, v201
    v_and_b32 v131, 0xffff0000, v201
    v_lshlrev_b32 v132, 16, v202
    v_and_b32 v133, 0xffff0000, v202
    v_lshlrev_b32 v134, 16, v203
    v_and_b32 v135, 0xffff0000, v203
    v_lshlrev_b32 v136, 16, v204
    v_and_b32 v137, 0xffff0000, v204
    v_lshlrev_b32 v138, 16, v205
    v_and_b32 v139, 0xffff0000, v205
    v_lshlrev_b32 v140, 16, v206
    v_and_b32 v141, 0xffff0000, v206
    v_lshlrev_b32 v142, 16, v207
    v_and_b32 v143, 0xffff0000, v207
    v_lshlrev_b32 v144, 16, v208
    v_and_b32 v145, 0xffff0000, v208
    v_lshlrev_b32 v146, 16, v209
    v_and_b32 v147, 0xffff0000, v209
    v_lshlrev_b32 v148, 16, v210
    v_and_b32 v149, 0xffff0000, v210
    v_lshlrev_b32 v150, 16, v211
    v_and_b32 v151, 0xffff0000, v211
    v_lshlrev_b32 v152, 16, v212
    v_and_b32 v153, 0xffff0000, v212
    v_lshlrev_b32 v154, 16, v213
    v_and_b32 v155, 0xffff0000, v213
    v_lshlrev_b32 v156, 16, v214
    v_and_b32 v157, 0xffff0000, v214
    v_lshlrev_b32 v158, 16, v215
    v_and_b32 v159, 0xffff0000, v215
    v_lshlrev_b32 v160, 16, v216
    v_and_b32 v161, 0xffff0000, v216
    v_lshlrev_b32 v162, 16, v217
    v_and_b32 v163, 0xffff0000, v217
    v_lshlrev_b32 v164, 16, v218
    v_and_b32 v165, 0xffff0000, v218
    v_lshlrev_b32 v166, 16, v219
    v_and_b32 v167, 0xffff0000, v219
    v_lshlrev_b32 v168, 16, v220
    v_and_b32 v169, 0xffff0000, v220
    v_lshlrev_b32 v170, 16, v221
    v_and_b32 v171, 0xffff0000, v221
    v_lshlrev_b32 v172, 16, v222
    v_and_b32 v173, 0xffff0000, v222
    v_lshlrev_b32 v174, 16, v223
    v_and_b32 v175, 0xffff0000, v223
    v_lshlrev_b32 v176, 16, v224
    v_and_b32 v177, 0xffff0000, v224
    v_lshlrev_b32 v178, 16, v225
    v_and_b32 v179, 0xffff0000, v225
    v_lshlrev_b32 v180, 16, v226
    v_and_b32 v181, 0xffff0000, v226
    v_lshlrev_b32 v182, 16, v227
    v_and_b32 v183, 0xffff0000, v227
    v_lshlrev_b32 v184, 16, v228
    v_and_b32 v185, 0xffff0000, v228
    v_lshlrev_b32 v186, 16, v229
    v_and_b32 v187, 0xffff0000, v229
    v_lshlrev_b32 v188, 16, v230
    v_and_b32 v189, 0xffff0000, v230
    v_lshlrev_b32 v190, 16, v231
    v_and_b32 v191, 0xffff0000, v231
    v_lshlrev_b32 v192, 16, v232
    v_and_b32 v193, 0xffff0000, v232
    v_lshlrev_b32 v194, 16, v233
    v_and_b32 v195, 0xffff0000, v233
    v_lshlrev_b32 v196, 16, v234
    v_and_b32 v197, 0xffff0000, v234
    v_lshlrev_b32 v198, 16, v235
    v_and_b32 v199, 0xffff0000, v235
    v_lshlrev_b32 v200, 16, v236
    v_and_b32 v201, 0xffff0000, v236
    v_lshlrev_b32 v202, 16, v237
    v_and_b32 v203, 0xffff0000, v237
    v_lshlrev_b32 v204, 16, v238
    v_and_b32 v205, 0xffff0000, v238
    v_lshlrev_b32 v206, 16, v239
    v_and_b32 v207, 0xffff0000, v239
    v_lshlrev_b32 v208, 16, v240
    v_and_b32 v209, 0xffff0000, v240
    v_lshlrev_b32 v210, 16, v241
    v_and_b32 v211, 0xffff0000, v241
    v_lshlrev_b32 v212, 16, v242
    v_and_b32 v213, 0xffff0000, v242
    v_lshlrev_b32 v214, 16, v243
    v_and_b32 v215, 0xffff0000, v243
    v_lshlrev_b32 v216, 16, v244
    v_and_b32 v217, 0xffff0000, v244
    v_lshlrev_b32 v218, 16, v245
    v_and_b32 v219, 0xffff0000, v245
    v_lshlrev_b32 v220, 16, v246
    v_and_b32 v221, 0xffff0000, v246
    v_lshlrev_b32 v222, 16, v247
    v_and_b32 v223, 0xffff0000, v247
    v_lshlrev_b32 v224, 16, v248
    v_and_b32 v225, 0xffff0000, v248
    v_lshlrev_b32 v226, 16, v249
    v_and_b32 v227, 0xffff0000, v249
    v_lshlrev_b32 v228, 16, v250
    v_and_b32 v229, 0xffff0000, v250
    v_lshlrev_b32 v230, 16, v251
    v_and_b32 v231, 0xffff0000, v251
    v_lshlrev_b32 v232, 16, v252
    v_and_b32 v233, 0xffff0000, v252
    v_lshlrev_b32 v234, 16, v253
    v_and_b32 v235, 0xffff0000, v253
    v_lshlrev_b32 v236, 16, v254
    v_and_b32 v237, 0xffff0000, v254
    v_lshlrev_b32 v238, 16, v255
    v_and_b32 v239, 0xffff0000, v255
    s_mov_b32 s69, 0
L_vloop:
    s_and_b32 s67, s20, 15
    s_lshl_b32 s67, s67, 15
    s_cmp_lt_u32 s20, 16
    s_cselect_b64 s[40:41], s[60:61], s[62:63]
    s_add_u32 s40, s40, s67
    s_addc_u32 s41, s41, 0
    s_cmp_lt_u32 s20, 32
    s_cselect_b32 s42, 4096, 0
    s_add_u32 s20, s20, 1
    s_waitcnt vmcnt(0)
    buffer_load_dwordx4 v[80:83], v2, s[40:43], 0 offen offset:0 nt
    buffer_load_dwordx4 v[84:87], v2, s[40:43], 0 offen offset:1024 nt
    buffer_load_dwordx4 v[88:91], v2, s[40:43], 0 offen offset:2048 nt
    buffer_load_dwordx4 v[92:95], v2, s[40:43], 0 offen offset:3072 nt
    v_lshlrev_b32 v24, 16, v64
    v_and_b32 v25, 0xffff0000, v64
    v_lshlrev_b32 v26, 16, v65
    v_and_b32 v27, 0xffff0000, v65
    v_lshlrev_b32 v28, 16, v66
    v_and_b32 v29, 0xffff0000, v66
    v_lshlrev_b32 v30, 16, v67
    v_and_b32 v31, 0xffff0000, v67
    v_fmac_f32_dpp v32, v12, v24 row_newbcast:0 row_mask:0xf bank_mask:0xf
    v_fmac_f32_dpp v33, v12, v25 row_newbcast:0 row_mask:0xf bank_mask:0xf
    v_fmac_f32_dpp v34, v12, v26 row_newbcast:0 row_mask:0xf bank_mask:0xf
    v_fmac_f32_dpp v35, v12, v27 row_newbcast:0 row_mask:0xf bank_mask:0xf
    v_fmac_f32_dpp v36, v12, v28 row_newbcast:0 row_mask:0xf bank_mask:0xf
    v_fmac_f32_dpp v37, v12, v29 row_newbcast:0 row_mask:0xf bank_mask:0xf
    v_fmac_f32_dpp v38, v12, v30 row_newbcast:0 row_mask:0xf bank_mask:0xf
    v_fmac_f32_dpp v39, v12, v31 row_newbcast:0 row_mask:0xf bank_mask:0xf
    v_lshlrev_b32 v24, 16, v68
    v_and_b32 v25, 0xffff0000, v68
    v_lshlrev_b32 v26, 16, v69
    v_and_b32 v27, 0xffff0000, v69
    v_lshlrev_b32 v28, 16, v70
    v_and_b32 v29, 0xffff0000, v70
    v_lshlrev_b32 v30, 16, v71
    v_and_b32 v31, 0xffff0000, v71
    v_fmac_f32_dpp v32, v12, v24 row_newbcast:1 row_mask:0xf bank_mask:0xf
    v_fmac_f32_dpp v33, v12, v25 row_newbcast:1 row_mask:0xf bank_mask:0xf
    v_fmac_f32_dpp v34, v12, v26 row_newbcast:1 row_mask:0xf bank_mask:0xf
    v_fmac_f32_dpp v35, v12, v27 row_newbcast:1 row_mask:0xf bank_mask:0xf
    v_fmac_f32_dpp v36, v12, v28 row_newbcast:1 row_mask:0xf bank_mask:0xf
    v_fmac_f32_dpp v37, v12, v29 row_newbcast:1 row_mask:0xf bank_mask:0xf
    v_fmac_f32_dpp v38, v12, v30 row_newbcast:1 row_mask:0xf bank_mask:0xf
    v_fmac_f32_dpp v39, v12, v31 row_newbcast:1 row_mask:0xf bank_mask:0xf
    v_lshlrev_b32 v24, 16, v72
    v_and_b32 v25, 0xffff0000, v72
    v_lshlrev_b32 v26, 16, v73
    v_and_b32 v27, 0xffff0000, v73
    v_lshlrev_b32 v28, 16, v74
    v_and_b32 v29, 0xffff0000, v74
    v_lshlrev_b32 v30, 16, v75
    v_and_b32 v31, 0xffff0000, v75
    v_fmac_f32_dpp v32, v12, v24 row_newbcast:2 row_mask:0xf bank_mask:0xf
    v_fmac_f32_dpp v33, v12, v25 row_newbcast:2 row_mask:0xf bank_mask:0xf
    v_fmac_f32_dpp v34, v12, v26 row_newbcast:2 row_mask:0xf bank_mask:0xf
    v_fmac_f32_dpp v35, v12, v27 row_newbcast:2 row_mask:0xf bank_mask:0xf
    v_fmac_f32_dpp v36, v12, v28 row_newbcast:2 row_mask:0xf bank_mask:0xf
    v_fmac_f32_dpp v37, v12, v29 row_newbcast:2 row_mask:0xf bank_mask:0xf
    v_fmac_f32_dpp v38, v12, v30 row_newbcast:2 row_mask:0xf bank_mask:0xf
    v_fmac_f32_dpp v39, v12, v31 row_newbcast:2 row_mask:0xf bank_mask:0xf
    v_lshlrev_b32 v24, 16, v76
    v_and_b32 v25, 0xffff0000, v76
    v_lshlrev_b32 v26, 16, v77
    v_and_b32 v27, 0xffff0000, v77
    v_lshlrev_b32 v28, 16, v78
    v_and_b32 v29, 0xffff0000, v78
    v_lshlrev_b32 v30, 16, v79
    v_and_b32 v31, 0xffff0000, v79
    v_fmac_f32_dpp v32, v12, v24 row_newbcast:3 row_mask:0xf bank_mask:0xf
    v_fmac_f32_dpp v33, v12, v25 row_newbcast:3 row_mask:0xf bank_mask:0xf
    v_fmac_f32_dpp v34, v12, v26 row_newbcast:3 row_mask:0xf bank_mask:0xf
    v_fmac_f32_dpp v35, v12, v27 row_newbcast:3 row_mask:0xf bank_mask:0xf
    v_fmac_f32_dpp v36, v12, v28 row_newbcast:3 row_mask:0xf bank_mask:0xf
    v_fmac_f32_dpp v37, v12, v29 row_newbcast:3 row_mask:0xf bank_mask:0xf
    v_fmac_f32_dpp v38, v12, v30 row_newbcast:3 row_mask:0xf bank_mask:0xf
    v_fmac_f32_dpp v39, v12, v31 row_newbcast:3 row_mask:0xf bank_mask:0xf
    s_and_b32 s67, s20, 15
    s_lshl_b32 s67, s67, 15
    s_cmp_lt_u32 s20, 16
    s_cselect_b64 s[40:41], s[60:61], s[62:63]
    s_add_u32 s40, s40, s67
    s_addc_u32 s41, s41, 0
    s_cmp_lt_u32 s20, 32
    s_cselect_b32 s42, 4096, 0
    s_add_u32 s20, s20, 1
    s_waitcnt vmcnt(0)
    buffer_load_dwordx4 v[64:67], v2, s[40:43], 0 offen offset:0 nt
    buffer_load_dwordx4 v[68:71], v2, s[40:43], 0 offen offset:1024 nt
    buffer_load_dwordx4 v[72:75], v2, s[40:43], 0 offen offset:2048 nt
    buffer_load_dwordx4 v[76:79], v2, s[40:43], 0 offen offset:3072 nt
    v_lshlrev_b32 v24, 16, v80
    v_and_b32 v25, 0xffff0000, v80
    v_lshlrev_b32 v26, 16, v81
    v_and_b32 v27, 0xffff0000, v81
    v_lshlrev_b32 v28, 16, v82
    v_and_b32 v29, 0xffff0000, v82
    v_lshlrev_b32 v30, 16, v83
    v_and_b32 v31, 0xffff0000, v83
    v_fmac_f32_dpp v32, v12, v24 row_newbcast:4 row_mask:0xf bank_mask:0xf
    v_fmac_f32_dpp v33, v12, v25 row_newbcast:4 row_mask:0xf bank_mask:0xf
    v_fmac_f32_dpp v34, v12, v26 row_newbcast:4 row_mask:0xf bank_mask:0xf
    v_fmac_f32_dpp v35, v12, v27 row_newbcast:4 row_mask:0xf bank_mask:0xf
    v_fmac_f32_dpp v36, v12, v28 row_newbcast:4 row_mask:0xf bank_mask:0xf
    v_fmac_f32_dpp v37, v12, v29 row_newbcast:4 row_mask:0xf bank_mask:0xf
    v_fmac_f32_dpp v38, v12, v30 row_newbcast:4 row_mask:0xf bank_mask:0xf
    v_fmac_f32_dpp v39, v12, v31 row_newbcast:4 row_mask:0xf bank_mask:0xf
    v_lshlrev_b32 v24, 16, v84
    v_and_b32 v25, 0xffff0000, v84
    v_lshlrev_b32 v26, 16, v85
    v_and_b32 v27, 0xffff0000, v85
    v_lshlrev_b32 v28, 16, v86
    v_and_b32 v29, 0xffff0000, v86
    v_lshlrev_b32 v30, 16, v87
    v_and_b32 v31, 0xffff0000, v87
    v_fmac_f32_dpp v32, v12, v24 row_newbcast:5 row_mask:0xf bank_mask:0xf
    v_fmac_f32_dpp v33, v12, v25 row_newbcast:5 row_mask:0xf bank_mask:0xf
    v_fmac_f32_dpp v34, v12, v26 row_newbcast:5 row_mask:0xf bank_mask:0xf
    v_fmac_f32_dpp v35, v12, v27 row_newbcast:5 row_mask:0xf bank_mask:0xf
    v_fmac_f32_dpp v36, v12, v28 row_newbcast:5 row_mask:0xf bank_mask:0xf
    v_fmac_f32_dpp v37, v12, v29 row_newbcast:5 row_mask:0xf bank_mask:0xf
    v_fmac_f32_dpp v38, v12, v30 row_newbcast:5 row_mask:0xf bank_mask:0xf
    v_fmac_f32_dpp v39, v12, v31 row_newbcast:5 row_mask:0xf bank_mask:0xf
    v_lshlrev_b32 v24, 16, v88
    v_and_b32 v25, 0xffff0000, v88
    v_lshlrev_b32 v26, 16, v89
    v_and_b32 v27, 0xffff0000, v89
    v_lshlrev_b32 v28, 16, v90
    v_and_b32 v29, 0xffff0000, v90
    v_lshlrev_b32 v30, 16, v91
    v_and_b32 v31, 0xffff0000, v91
    v_fmac_f32_dpp v32, v12, v24 row_newbcast:6 row_mask:0xf bank_mask:0xf
    v_fmac_f32_dpp v33, v12, v25 row_newbcast:6 row_mask:0xf bank_mask:0xf
    v_fmac_f32_dpp v34, v12, v26 row_newbcast:6 row_mask:0xf bank_mask:0xf
    v_fmac_f32_dpp v35, v12, v27 row_newbcast:6 row_mask:0xf bank_mask:0xf
    v_fmac_f32_dpp v36, v12, v28 row_newbcast:6 row_mask:0xf bank_mask:0xf
    v_fmac_f32_dpp v37, v12, v29 row_newbcast:6 row_mask:0xf bank_mask:0xf
    v_fmac_f32_dpp v38, v12, v30 row_newbcast:6 row_mask:0xf bank_mask:0xf
    v_fmac_f32_dpp v39, v12, v31 row_newbcast:6 row_mask:0xf bank_mask:0xf
    v_lshlrev_b32 v24, 16, v92
    v_and_b32 v25, 0xffff0000, v92
    v_lshlrev_b32 v26, 16, v93
    v_and_b32 v27, 0xffff0000, v93
    v_lshlrev_b32 v28, 16, v94
    v_and_b32 v29, 0xffff0000, v94
    v_lshlrev_b32 v30, 16, v95
    v_and_b32 v31, 0xffff0000, v95
    v_fmac_f32_dpp v32, v12, v24 row_newbcast:7 row_mask:0xf bank_mask:0xf
    v_fmac_f32_dpp v33, v12, v25 row_newbcast:7 row_mask:0xf bank_mask:0xf
    v_fmac_f32_dpp v34, v12, v26 row_newbcast:7 row_mask:0xf bank_mask:0xf
    v_fmac_f32_dpp v35, v12, v27 row_newbcast:7 row_mask:0xf bank_mask:0xf
    v_fmac_f32_dpp v36, v12, v28 row_newbcast:7 row_mask:0xf bank_mask:0xf
    v_fmac_f32_dpp v37, v12, v29 row_newbcast:7 row_mask:0xf bank_mask:0xf
    v_fmac_f32_dpp v38, v12, v30 row_newbcast:7 row_mask:0xf bank_mask:0xf
    v_fmac_f32_dpp v39, v12, v31 row_newbcast:7 row_mask:0xf bank_mask:0xf
    s_and_b32 s67, s20, 15
    s_lshl_b32 s67, s67, 15
    s_cmp_lt_u32 s20, 16
    s_cselect_b64 s[40:41], s[60:61], s[62:63]
    s_add_u32 s40, s40, s67
    s_addc_u32 s41, s41, 0
    s_cmp_lt_u32 s20, 32
    s_cselect_b32 s42, 4096, 0
    s_add_u32 s20, s20, 1
    s_waitcnt vmcnt(0)
    buffer_load_dwordx4 v[80:83], v2, s[40:43], 0 offen offset:0 nt
    buffer_load_dwordx4 v[84:87], v2, s[40:43], 0 offen offset:1024 nt
    buffer_load_dwordx4 v[88:91], v2, s[40:43], 0 offen offset:2048 nt
    buffer_load_dwordx4 v[92:95], v2, s[40:43], 0 offen offset:3072 nt
    v_lshlrev_b32 v24, 16, v64
    v_and_b32 v25, 0xffff0000, v64
    v_lshlrev_b32 v26, 16, v65
    v_and_b32 v27, 0xffff0000, v65
    v_lshlrev_b32 v28, 16, v66
    v_and_b32 v29, 0xffff0000, v66
    v_lshlrev_b32 v30, 16, v67
    v_and_b32 v31, 0xffff0000, v67
    v_fmac_f32_dpp v32, v12, v24 row_newbcast:8 row_mask:0xf bank_mask:0xf
    v_fmac_f32_dpp v33, v12, v25 row_newbcast:8 row_mask:0xf bank_mask:0xf
    v_fmac_f32_dpp v34, v12, v26 row_newbcast:8 row_mask:0xf bank_mask:0xf
    v_fmac_f32_dpp v35, v12, v27 row_newbcast:8 row_mask:0xf bank_mask:0xf
    v_fmac_f32_dpp v36, v12, v28 row_newbcast:8 row_mask:0xf bank_mask:0xf
    v_fmac_f32_dpp v37, v12, v29 row_newbcast:8 row_mask:0xf bank_mask:0xf
    v_fmac_f32_dpp v38, v12, v30 row_newbcast:8 row_mask:0xf bank_mask:0xf
    v_fmac_f32_dpp v39, v12, v31 row_newbcast:8 row_mask:0xf bank_mask:0xf
    v_lshlrev_b32 v24, 16, v68
    v_and_b32 v25, 0xffff0000, v68
    v_lshlrev_b32 v26, 16, v69
    v_and_b32 v27, 0xffff0000, v69
    v_lshlrev_b32 v28, 16, v70
    v_and_b32 v29, 0xffff0000, v70
    v_lshlrev_b32 v30, 16, v71
    v_and_b32 v31, 0xffff0000, v71
    v_fmac_f32_dpp v32, v12, v24 row_newbcast:9 row_mask:0xf bank_mask:0xf
    v_fmac_f32_dpp v33, v12, v25 row_newbcast:9 row_mask:0xf bank_mask:0xf
    v_fmac_f32_dpp v34, v12, v26 row_newbcast:9 row_mask:0xf bank_mask:0xf
    v_fmac_f32_dpp v35, v12, v27 row_newbcast:9 row_mask:0xf bank_mask:0xf
    v_fmac_f32_dpp v36, v12, v28 row_newbcast:9 row_mask:0xf bank_mask:0xf
    v_fmac_f32_dpp v37, v12, v29 row_newbcast:9 row_mask:0xf bank_mask:0xf
    v_fmac_f32_dpp v38, v12, v30 row_newbcast:9 row_mask:0xf bank_mask:0xf
    v_fmac_f32_dpp v39, v12, v31 row_newbcast:9 row_mask:0xf bank_mask:0xf
    v_lshlrev_b32 v24, 16, v72
    v_and_b32 v25, 0xffff0000, v72
    v_lshlrev_b32 v26, 16, v73
    v_and_b32 v27, 0xffff0000, v73
    v_lshlrev_b32 v28, 16, v74
    v_and_b32 v29, 0xffff0000, v74
    v_lshlrev_b32 v30, 16, v75
    v_and_b32 v31, 0xffff0000, v75
    v_fmac_f32_dpp v32, v12, v24 row_newbcast:10 row_mask:0xf bank_mask:0xf
    v_fmac_f32_dpp v33, v12, v25 row_newbcast:10 row_mask:0xf bank_mask:0xf
    v_fmac_f32_dpp v34, v12, v26 row_newbcast:10 row_mask:0xf bank_mask:0xf
    v_fmac_f32_dpp v35, v12, v27 row_newbcast:10 row_mask:0xf bank_mask:0xf
    v_fmac_f32_dpp v36, v12, v28 row_newbcast:10 row_mask:0xf bank_mask:0xf
    v_fmac_f32_dpp v37, v12, v29 row_newbcast:10 row_mask:0xf bank_mask:0xf
    v_fmac_f32_dpp v38, v12, v30 row_newbcast:10 row_mask:0xf bank_mask:0xf
    v_fmac_f32_dpp v39, v12, v31 row_newbcast:10 row_mask:0xf bank_mask:0xf
    v_lshlrev_b32 v24, 16, v76
    v_and_b32 v25, 0xffff0000, v76
    v_lshlrev_b32 v26, 16, v77
    v_and_b32 v27, 0xffff0000, v77
    v_lshlrev_b32 v28, 16, v78
    v_and_b32 v29, 0xffff0000, v78
    v_lshlrev_b32 v30, 16, v79
    v_and_b32 v31, 0xffff0000, v79
    v_fmac_f32_dpp v32, v12, v24 row_newbcast:11 row_mask:0xf bank_mask:0xf
    v_fmac_f32_dpp v33, v12, v25 row_newbcast:11 row_mask:0xf bank_mask:0xf
    v_fmac_f32_dpp v34, v12, v26 row_newbcast:11 row_mask:0xf bank_mask:0xf
    v_fmac_f32_dpp v35, v12, v27 row_newbcast:11 row_mask:0xf bank_mask:0xf
    v_fmac_f32_dpp v36, v12, v28 row_newbcast:11 row_mask:0xf bank_mask:0xf
    v_fmac_f32_dpp v37, v12, v29 row_newbcast:11 row_mask:0xf bank_mask:0xf
    v_fmac_f32_dpp v38, v12, v30 row_newbcast:11 row_mask:0xf bank_mask:0xf
    v_fmac_f32_dpp v39, v12, v31 row_newbcast:11 row_mask:0xf bank_mask:0xf
    s_and_b32 s67, s20, 15
    s_lshl_b32 s67, s67, 15
    s_cmp_lt_u32 s20, 16
    s_cselect_b64 s[40:41], s[60:61], s[62:63]
    s_add_u32 s40, s40, s67
    s_addc_u32 s41, s41, 0
    s_cmp_lt_u32 s20, 32
    s_cselect_b32 s42, 4096, 0
    s_add_u32 s20, s20, 1
    s_waitcnt vmcnt(0)
    buffer_load_dwordx4 v[64:67], v2, s[40:43], 0 offen offset:0 nt
    buffer_load_dwordx4 v[68:71], v2, s[40:43], 0 offen offset:1024 nt
    buffer_load_dwordx4 v[72:75], v2, s[40:43], 0 offen offset:2048 nt
    buffer_load_dwordx4 v[76:79], v2, s[40:43], 0 offen offset:3072 nt
    v_lshlrev_b32 v24, 16, v80
    v_and_b32 v25, 0xffff0000, v80
    v_lshlrev_b32 v26, 16, v81
    v_and_b32 v27, 0xffff0000, v81
    v_lshlrev_b32 v28, 16, v82
    v_and_b32 v29, 0xffff0000, v82
    v_lshlrev_b32 v30, 16, v83
    v_and_b32 v31, 0xffff0000, v83
    v_fmac_f32_dpp v32, v12, v24 row_newbcast:12 row_mask:0xf bank_mask:0xf
    v_fmac_f32_dpp v33, v12, v25 row_newbcast:12 row_mask:0xf bank_mask:0xf
    v_fmac_f32_dpp v34, v12, v26 row_newbcast:12 row_mask:0xf bank_mask:0xf
    v_fmac_f32_dpp v35, v12, v27 row_newbcast:12 row_mask:0xf bank_mask:0xf
    v_fmac_f32_dpp v36, v12, v28 row_newbcast:12 row_mask:0xf bank_mask:0xf
    v_fmac_f32_dpp v37, v12, v29 row_newbcast:12 row_mask:0xf bank_mask:0xf
    v_fmac_f32_dpp v38, v12, v30 row_newbcast:12 row_mask:0xf bank_mask:0xf
    v_fmac_f32_dpp v39, v12, v31 row_newbcast:12 row_mask:0xf bank_mask:0xf
    v_lshlrev_b32 v24, 16, v84
    v_and_b32 v25, 0xffff0000, v84
    v_lshlrev_b32 v26, 16, v85
    v_and_b32 v27, 0xffff0000, v85
    v_lshlrev_b32 v28, 16, v86
    v_and_b32 v29, 0xffff0000, v86
    v_lshlrev_b32 v30, 16, v87
    v_and_b32 v31, 0xffff0000, v87
    v_fmac_f32_dpp v32, v12, v24 row_newbcast:13 row_mask:0xf bank_mask:0xf
    v_fmac_f32_dpp v33, v12, v25 row_newbcast:13 row_mask:0xf bank_mask:0xf
    v_fmac_f32_dpp v34, v12, v26 row_newbcast:13 row_mask:0xf bank_mask:0xf
    v_fmac_f32_dpp v35, v12, v27 row_newbcast:13 row_mask:0xf bank_mask:0xf
    v_fmac_f32_dpp v36, v12, v28 row_newbcast:13 row_mask:0xf bank_mask:0xf
    v_fmac_f32_dpp v37, v12, v29 row_newbcast:13 row_mask:0xf bank_mask:0xf
    v_fmac_f32_dpp v38, v12, v30 row_newbcast:13 row_mask:0xf bank_mask:0xf
    v_fmac_f32_dpp v39, v12, v31 row_newbcast:13 row_mask:0xf bank_mask:0xf
    v_lshlrev_b32 v24, 16, v88
    v_and_b32 v25, 0xffff0000, v88
    v_lshlrev_b32 v26, 16, v89
    v_and_b32 v27, 0xffff0000, v89
    v_lshlrev_b32 v28, 16, v90
    v_and_b32 v29, 0xffff0000, v90
    v_lshlrev_b32 v30, 16, v91
    v_and_b32 v31, 0xffff0000, v91
    v_fmac_f32_dpp v32, v12, v24 row_newbcast:14 row_mask:0xf bank_mask:0xf
    v_fmac_f32_dpp v33, v12, v25 row_newbcast:14 row_mask:0xf bank_mask:0xf
    v_fmac_f32_dpp v34, v12, v26 row_newbcast:14 row_mask:0xf bank_mask:0xf
    v_fmac_f32_dpp v35, v12, v27 row_newbcast:14 row_mask:0xf bank_mask:0xf
    v_fmac_f32_dpp v36, v12, v28 row_newbcast:14 row_mask:0xf bank_mask:0xf
    v_fmac_f32_dpp v37, v12, v29 row_newbcast:14 row_mask:0xf bank_mask:0xf
    v_fmac_f32_dpp v38, v12, v30 row_newbcast:14 row_mask:0xf bank_mask:0xf
    v_fmac_f32_dpp v39, v12, v31 row_newbcast:14 row_mask:0xf bank_mask:0xf
    v_lshlrev_b32 v24, 16, v92
    v_and_b32 v25, 0xffff0000, v92
    v_lshlrev_b32 v26, 16, v93
    v_and_b32 v27, 0xffff0000, v93
    v_lshlrev_b32 v28, 16, v94
    v_and_b32 v29, 0xffff0000, v94
    v_lshlrev_b32 v30, 16, v95
    v_and_b32 v31, 0xffff0000, v95
    v_fmac_f32_dpp v32, v12, v24 row_newbcast:15 row_mask:0xf bank_mask:0xf
    v_fmac_f32_dpp v33, v12, v25 row_newbcast:15 row_mask:0xf bank_mask:0xf
    v_fmac_f32_dpp v34, v12, v26 row_newbcast:15 row_mask:0xf bank_mask:0xf
    v_fmac_f32_dpp v35, v12, v27 row_newbcast:15 row_mask:0xf bank_mask:0xf
    v_fmac_f32_dpp v36, v12, v28 row_newbcast:15 row_mask:0xf bank_mask:0xf
    v_fmac_f32_dpp v37, v12, v29 row_newbcast:15 row_mask:0xf bank_mask:0xf
    v_fmac_f32_dpp v38, v12, v30 row_newbcast:15 row_mask:0xf bank_mask:0xf
    v_fmac_f32_dpp v39, v12, v31 row_newbcast:15 row_mask:0xf bank_mask:0xf
    v_mov_b32 v12, v13
    v_mov_b32 v13, v14
    v_mov_b32 v14, v15
    s_add_u32 s69, s69, 1
    s_cmp_lt_u32 s69, 4
    s_cbranch_scc1 L_vloop
    s_nop 1
    v_permlane32_swap_b32 v32, v36
    v_permlane32_swap_b32 v33, v37
    v_permlane32_swap_b32 v34, v38
    v_permlane32_swap_b32 v35, v39
    s_nop 1
    v_add_f32 v32, v32, v36
    v_add_f32 v33, v33, v37
    v_add_f32 v34, v34, v38
    v_add_f32 v35, v35, v39
    s_nop 1
    v_permlane16_swap_b32 v32, v34
    v_permlane16_swap_b32 v33, v35
    s_nop 1
    v_add_f32 v32, v32, v34
    v_add_f32 v33, v33, v35
    ds_write_b64 v42, v[32:33] offset:4096
    v_mov_b32 v5, 0
    s_lshl_b32 s67, s3, 6
    v_lshl_add_u32 v7, v6, 2, s67
    s_waitcnt lgkmcnt(0)
    s_barrier
    ds_read_b128 v[96:99], v5 offset:8192
    ds_read_b128 v[100:103], v5 offset:8208
    ds_read_b128 v[104:107], v5 offset:8224
    ds_read_b128 v[108:111], v5 offset:8240
    ds_read_b32 v44, v7 offset:4096
    ds_read_b32 v45, v7 offset:4608
    ds_read_b32 v46, v7 offset:5120
    ds_read_b32 v47, v7 offset:5632
    ds_read_b32 v48, v7 offset:6144
    ds_read_b32 v49, v7 offset:6656
    ds_read_b32 v50, v7 offset:7168
    ds_read_b32 v51, v7 offset:7680
    s_waitcnt lgkmcnt(8)
    v_max3_f32 v40, v96, v98, v100
    v_max3_f32 v40, v40, v102, v104
    v_max3_f32 v40, v40, v106, v108
    v_max_f32 v40, v40, v110
    v_sub_f32 v96, v96, v40
    v_sub_f32 v98, v98, v40
    v_sub_f32 v100, v100, v40
    v_sub_f32 v102, v102, v40
    v_sub_f32 v104, v104, v40
    v_sub_f32 v106, v106, v40
    v_sub_f32 v108, v108, v40
    v_sub_f32 v110, v110, v40
    v_mul_f32 v96, s65, v96
    v_mul_f32 v98, s65, v98
    v_mul_f32 v100, s65, v100
    v_mul_f32 v102, s65, v102
    v_mul_f32 v104, s65, v104
    v_mul_f32 v106, s65, v106
    v_mul_f32 v108, s65, v108
    v_mul_f32 v110, s65, v110
    v_exp_f32 v96, v96
    v_exp_f32 v98, v98
    v_exp_f32 v100, v100
    v_exp_f32 v102, v102
    v_exp_f32 v104, v104
    v_exp_f32 v106, v106
    v_exp_f32 v108, v108
    v_exp_f32 v110, v110
    s_waitcnt lgkmcnt(0)
    v_mul_f32 v12, v96, v44
    v_fmac_f32 v12, v98, v45
    v_fmac_f32 v12, v100, v46
    v_fmac_f32 v12, v102, v47
    v_fmac_f32 v12, v104, v48
    v_fmac_f32 v12, v106, v49
    v_fmac_f32 v12, v108, v50
    v_fmac_f32 v12, v110, v51
    v_mul_f32 v41, v96, v97
    v_fmac_f32 v41, v98, v99
    v_fmac_f32 v41, v100, v101
    v_fmac_f32 v41, v102, v103
    v_fmac_f32 v41, v104, v105
    v_fmac_f32 v41, v106, v107
    v_fmac_f32 v41, v108, v109
    v_fmac_f32 v41, v110, v111
    s_nop 0
    v_readlane_b32 s70, v12, 0
    v_readlane_b32 s71, v12, 1
    v_readlane_b32 s72, v12, 2
    v_readlane_b32 s73, v12, 3
    v_readlane_b32 s74, v12, 4
    v_readlane_b32 s75, v12, 5
    v_readlane_b32 s76, v12, 6
    v_readlane_b32 s77, v12, 7
    v_readlane_b32 s78, v12, 8
    v_readlane_b32 s79, v12, 9
    v_readlane_b32 s80, v12, 10
    v_readlane_b32 s81, v12, 11
    v_readlane_b32 s82, v12, 12
    v_readlane_b32 s83, v12, 13
    v_readlane_b32 s84, v12, 14
    v_readlane_b32 s85, v12, 15
    s_nop 1
    v_pk_mul_f32 v[32:33], v[112:113], s[70:71] op_sel_hi:[1,0]
    v_pk_mul_f32 v[34:35], v[114:115], s[70:71] op_sel_hi:[1,0]
    v_pk_mul_f32 v[36:37], v[116:117], s[70:71] op_sel_hi:[1,0]
    v_pk_mul_f32 v[38:39], v[118:119], s[70:71] op_sel_hi:[1,0]
    v_pk_fma_f32 v[32:33], v[120:121], s[70:71], v[32:33] op_sel:[0,1,0] op_sel_hi:[1,1,1]
    v_pk_fma_f32 v[34:35], v[122:123], s[70:71], v[34:35] op_sel:[0,1,0] op_sel_hi:[1,1,1]
    v_pk_fma_f32 v[36:37], v[124:125], s[70:71], v[36:37] op_sel:[0,1,0] op_sel_hi:[1,1,1]
    v_pk_fma_f32 v[38:39], v[126:127], s[70:71], v[38:39] op_sel:[0,1,0] op_sel_hi:[1,1,1]
    v_pk_fma_f32 v[32:33], v[128:129], s[72:73], v[32:33] op_sel_hi:[1,0,1]
    v_pk_fma_f32 v[34:35], v[130:131], s[72:73], v[34:35] op_sel_hi:[1,0,1]
    v_pk_fma_f32 v[36:37], v[132:133], s[72:73], v[36:37] op_sel_hi:[1,0,1]
    v_pk_fma_f32 v[38:39], v[134:135], s[72:73], v[38:39] op_sel_hi:[1,0,1]
    v_pk_fma_f32 v[32:33], v[136:137], s[72:73], v[32:33] op_sel:[0,1,0] op_sel_hi:[1,1,1]
    v_pk_fma_f32 v[34:35], v[138:139], s[72:73], v[34:35] op_sel:[0,1,0] op_sel_hi:[1,1,1]
    v_pk_fma_f32 v[36:37], v[140:141], s[72:73], v[36:37] op_sel:[0,1,0] op_sel_hi:[1,1,1]
    v_pk_fma_f32 v[38:39], v[142:143], s[72:73], v[38:39] op_sel:[0,1,0] op_sel_hi:[1,1,1]
    v_pk_fma_f32 v[32:33], v[144:145], s[74:75], v[32:33] op_sel_hi:[1,0,1]
    v_pk_fma_f32 v[34:35], v[146:147], s[74:75], v[34:35] op_sel_hi:[1,0,1]
    v_pk_fma_f32 v[36:37], v[148:149], s[74:75], v[36:37] op_sel_hi:[1,0,1]
    v_pk_fma_f32 v[38:39], v[150:151], s[74:75], v[38:39] op_sel_hi:[1,0,1]
    v_pk_fma_f32 v[32:33], v[152:153], s[74:75], v[32:33] op_sel:[0,1,0] op_sel_hi:[1,1,1]
    v_pk_fma_f32 v[34:35], v[154:155], s[74:75], v[34:35] op_sel:[0,1,0] op_sel_hi:[1,1,1]
    v_pk_fma_f32 v[36:37], v[156:157], s[74:75], v[36:37] op_sel:[0,1,0] op_sel_hi:[1,1,1]
    v_pk_fma_f32 v[38:39], v[158:159], s[74:75], v[38:39] op_sel:[0,1,0] op_sel_hi:[1,1,1]
    v_pk_fma_f32 v[32:33], v[160:161], s[76:77], v[32:33] op_sel_hi:[1,0,1]
    v_pk_fma_f32 v[34:35], v[162:163], s[76:77], v[34:35] op_sel_hi:[1,0,1]
    v_pk_fma_f32 v[36:37], v[164:165], s[76:77], v[36:37] op_sel_hi:[1,0,1]
    v_pk_fma_f32 v[38:39], v[166:167], s[76:77], v[38:39] op_sel_hi:[1,0,1]
    v_pk_fma_f32 v[32:33], v[168:169], s[76:77], v[32:33] op_sel:[0,1,0] op_sel_hi:[1,1,1]
    v_pk_fma_f32 v[34:35], v[170:171], s[76:77], v[34:35] op_sel:[0,1,0] op_sel_hi:[1,1,1]
    v_pk_fma_f32 v[36:37], v[172:173], s[76:77], v[36:37] op_sel:[0,1,0] op_sel_hi:[1,1,1]
    v_pk_fma_f32 v[38:39], v[174:175], s[76:77], v[38:39] op_sel:[0,1,0] op_sel_hi:[1,1,1]
    v_pk_fma_f32 v[32:33], v[176:177], s[78:79], v[32:33] op_sel_hi:[1,0,1]
    v_pk_fma_f32 v[34:35], v[178:179], s[78:79], v[34:35] op_sel_hi:[1,0,1]
    v_pk_fma_f32 v[36:37], v[180:181], s[78:79], v[36:37] op_sel_hi:[1,0,1]
    v_pk_fma_f32 v[38:39], v[182:183], s[78:79], v[38:39] op_sel_hi:[1,0,1]
    v_pk_fma_f32 v[32:33], v[184:185], s[78:79], v[32:33] op_sel:[0,1,0] op_sel_hi:[1,1,1]
    v_pk_fma_f32 v[34:35], v[186:187], s[78:79], v[34:35] op_sel:[0,1,0] op_sel_hi:[1,1,1]
    v_pk_fma_f32 v[36:37], v[188:189], s[78:79], v[36:37] op_sel:[0,1,0] op_sel_hi:[1,1,1]
    v_pk_fma_f32 v[38:39], v[190:191], s[78:79], v[38:39] op_sel:[0,1,0] op_sel_hi:[1,1,1]
    v_pk_fma_f32 v[32:33], v[192:193], s[80:81], v[32:33] op_sel_hi:[1,0,1]
    v_pk_fma_f32 v[34:35], v[194:195], s[80:81], v[34:35] op_sel_hi:[1,0,1]
    v_pk_fma_f32 v[36:37], v[196:197], s[80:81], v[36:37] op_sel_hi:[1,0,1]
    v_pk_fma_f32 v[38:39], v[198:199], s[80:81], v[38:39] op_sel_hi:[1,0,1]
    v_pk_fma_f32 v[32:33], v[200:201], s[80:81], v[32:33] op_sel:[0,1,0] op_sel_hi:[1,1,1]
    v_pk_fma_f32 v[34:35], v[202:203], s[80:81], v[34:35] op_sel:[0,1,0] op_sel_hi:[1,1,1]
    v_pk_fma_f32 v[36:37], v[204:205], s[80:81], v[36:37] op_sel:[0,1,0] op_sel_hi:[1,1,1]
    v_pk_fma_f32 v[38:39], v[206:207], s[80:81], v[38:39] op_sel:[0,1,0] op_sel_hi:[1,1,1]
    v_pk_fma_f32 v[32:33], v[208:209], s[82:83], v[32:33] op_sel_hi:[1,0,1]
    v_pk_fma_f32 v[34:35], v[210:211], s[82:83], v[34:35] op_sel_hi:[1,0,1]
    v_pk_fma_f32 v[36:37], v[212:213], s[82:83], v[36:37] op_sel_hi:[1,0,1]
    v_pk_fma_f32 v[38:39], v[214:215], s[82:83], v[38:39] op_sel_hi:[1,0,1]
    v_pk_fma_f32 v[32:33], v[216:217], s[82:83], v[32:33] op_sel:[0,1,0] op_sel_hi:[1,1,1]
    v_pk_fma_f32 v[34:35], v[218:219], s[82:83], v[34:35] op_sel:[0,1,0] op_sel_hi:[1,1,1]
    v_pk_fma_f32 v[36:37], v[220:221], s[82:83], v[36:37] op_sel:[0,1,0] op_sel_hi:[1,1,1]
    v_pk_fma_f32 v[38:39], v[222:223], s[82:83], v[38:39] op_sel:[0,1,0] op_sel_hi:[1,1,1]
    v_pk_fma_f32 v[32:33], v[224:225], s[84:85], v[32:33] op_sel_hi:[1,0,1]
    v_pk_fma_f32 v[34:35], v[226:227], s[84:85], v[34:35] op_sel_hi:[1,0,1]
    v_pk_fma_f32 v[36:37], v[228:229], s[84:85], v[36:37] op_sel_hi:[1,0,1]
    v_pk_fma_f32 v[38:39], v[230:231], s[84:85], v[38:39] op_sel_hi:[1,0,1]
    v_pk_fma_f32 v[32:33], v[232:233], s[84:85], v[32:33] op_sel:[0,1,0] op_sel_hi:[1,1,1]
    v_pk_fma_f32 v[34:35], v[234:235], s[84:85], v[34:35] op_sel:[0,1,0] op_sel_hi:[1,1,1]
    v_pk_fma_f32 v[36:37], v[236:237], s[84:85], v[36:37] op_sel:[0,1,0] op_sel_hi:[1,1,1]
    v_pk_fma_f32 v[38:39], v[238:239], s[84:85], v[38:39] op_sel:[0,1,0] op_sel_hi:[1,1,1]
    s_lshl_b32 s67, s3, 11
    v_lshl_add_u32 v5, v1, 5, s67
    ds_write_b128 v5, v[32:35] offset:8448
    ds_write_b128 v5, v[36:39] offset:8464
    v_lshlrev_b32 v5, 4, v0
    s_waitcnt vmcnt(0) lgkmcnt(0)
    s_barrier
    s_cmp_ge_u32 s3, 2
    s_cbranch_scc1 L_stored
    ds_read_b128 v[64:67], v5 offset:8448
    ds_read_b128 v[68:71], v5 offset:10496
    ds_read_b128 v[72:75], v5 offset:12544
    ds_read_b128 v[76:79], v5 offset:14592
    ds_read_b128 v[80:83], v5 offset:16640
    ds_read_b128 v[84:87], v5 offset:18688
    ds_read_b128 v[88:91], v5 offset:20736
    ds_read_b128 v[92:95], v5 offset:22784
    s_lshl_b32 s67, s2, 11
    s_lshl_b32 s68, s2, 3
    s_add_u32 s68, s68, 524288
    s_waitcnt lgkmcnt(0)
    v_add_f32 v64, v64, v68
    v_add_f32 v65, v65, v69
    v_add_f32 v66, v66, v70
    v_add_f32 v67, v67, v71
    v_add_f32 v64, v64, v72
    v_add_f32 v65, v65, v73
    v_add_f32 v66, v66, v74
    v_add_f32 v67, v67, v75
    v_add_f32 v64, v64, v76
    v_add_f32 v65, v65, v77
    v_add_f32 v66, v66, v78
    v_add_f32 v67, v67, v79
    v_add_f32 v64, v64, v80
    v_add_f32 v65, v65, v81
    v_add_f32 v66, v66, v82
    v_add_f32 v67, v67, v83
    v_add_f32 v64, v64, v84
    v_add_f32 v65, v65, v85
    v_add_f32 v66, v66, v86
    v_add_f32 v67, v67, v87
    v_add_f32 v64, v64, v88
    v_add_f32 v65, v65, v89
    v_add_f32 v66, v66, v90
    v_add_f32 v67, v67, v91
    v_add_f32 v64, v64, v92
    v_add_f32 v65, v65, v93
    v_add_f32 v66, v66, v94
    v_add_f32 v67, v67, v95
    buffer_store_dwordx4 v[64:67], v5, s[56:59], s67 offen sc1
    s_cmp_lg_u32 s3, 0
    s_cbranch_scc1 L_stored
    s_mov_b64 exec, 1
    buffer_store_dwordx2 v[40:41], v5, s[56:59], s68 offen sc1
    s_mov_b64 exec, -1
L_stored:
    s_mov_b32 s48, s10
    s_mov_b32 s49, s11
    s_mov_b32 s50, 256
    s_mov_b32 s51, 0x00020000
    s_mov_b32 s44, s8
    s_mov_b32 s45, s9
    s_mov_b32 s46, 2048
    s_mov_b32 s47, 0x00020000
    v_mov_b32 v5, 0
    s_waitcnt vmcnt(0)
    s_barrier
    s_cmp_lg_u32 s3, 0
    s_cbranch_scc1 L_wait_role
    v_mov_b32 v7, 1
    s_mov_b64 exec, 1
    buffer_atomic_add v7, v5, s[48:51], 0 offen sc0
    s_waitcnt vmcnt(0)
    s_mov_b64 exec, -1
    v_readfirstlane_b32 s67, v7
    s_nop 3
    s_cmp_lt_u32 s67, 224
    s_cbranch_scc1 L_publish
    s_cmp_eq_u32 s67, 255
    s_cbranch_scc1 L_publish
    s_mov_b32 s69, 0
L_poll:
    s_mov_b64 exec, 1
    buffer_load_dword v7, v5, s[48:51], 0 offen sc1
    s_waitcnt vmcnt(0)
    s_mov_b64 exec, -1
    v_readfirstlane_b32 s68, v7
    s_nop 3
    s_cmp_ge_u32 s68, 256
    s_cbranch_scc1 L_publish
    s_add_u32 s69, s69, 1
    s_cmp_lt_u32 s69, 0x100000
    s_cbranch_scc0 L_publish
    s_sleep 1
    s_branch L_poll
L_publish:
    v_mov_b32 v7, s67
    ds_write_b32 v5, v7 offset:8320
    s_waitcnt lgkmcnt(0)
L_wait_role:
    s_barrier
    s_cmp_ge_u32 s3, 4
    s_cbranch_scc1 L_end
    ds_read_b32 v7, v5 offset:8320
    s_waitcnt lgkmcnt(0)
    v_readfirstlane_b32 s67, v7
    s_nop 3
    s_cmp_lt_u32 s67, 224
    s_cbranch_scc1 L_end
    s_sub_u32 s67, s67, 224
    s_lshr_b32 s6, s67, 4
    s_and_b32 s7, s67, 15
    v_lshrrev_b32 v1, 3, v0
    v_and_b32 v2, 7, v0
    s_lshl_b32 s67, s6, 5
    v_add_u32 v3, s67, v1
    s_lshl_b32 s68, s7, 7
    v_lshl_add_u32 v4, v2, 4, s68
    v_lshl_add_u32 v4, v3, 11, v4
    v_lshlrev_b32 v5, 3, v3
    s_mov_b32 s16, 524288
    s_mov_b32 s20, 0
    s_mov_b32 s17, 524800
    s_mov_b32 s21, 131072
    s_mov_b32 s18, 525312
    s_mov_b32 s22, 262144
    s_mov_b32 s19, 525824
    s_mov_b32 s23, 393216
    buffer_load_dwordx2 v[8:9], v5, s[56:59], s16 offen sc1
    buffer_load_dwordx2 v[10:11], v5, s[56:59], s17 offen sc1
    buffer_load_dwordx2 v[12:13], v5, s[56:59], s18 offen sc1
    buffer_load_dwordx2 v[14:15], v5, s[56:59], s19 offen sc1
    buffer_load_dwordx4 v[16:19], v4, s[56:59], s20 offen sc1
    buffer_load_dwordx4 v[20:23], v4, s[56:59], s21 offen sc1
    buffer_load_dwordx4 v[24:27], v4, s[56:59], s22 offen sc1
    buffer_load_dwordx4 v[28:31], v4, s[56:59], s23 offen sc1
    s_waitcnt vmcnt(4)
    v_max3_f32 v6, v8, v10, v12
    v_max_f32 v6, v6, v14
    v_sub_f32 v8, v8, v6
    v_sub_f32 v10, v10, v6
    v_sub_f32 v12, v12, v6
    v_sub_f32 v14, v14, v6
    v_mul_f32 v8, s65, v8
    v_mul_f32 v10, s65, v10
    v_mul_f32 v12, s65, v12
    v_mul_f32 v14, s65, v14
    v_exp_f32 v8, v8
    v_exp_f32 v10, v10
    v_exp_f32 v12, v12
    v_exp_f32 v14, v14
    s_nop 0
    v_mul_f32 v7, v8, v9
    v_fmac_f32 v7, v10, v11
    v_fmac_f32 v7, v12, v13
    v_fmac_f32 v7, v14, v15
    v_rcp_f32 v7, v7
    s_nop 0
    v_mul_f32 v8, v8, v7
    v_mul_f32 v10, v10, v7
    v_mul_f32 v12, v12, v7
    v_mul_f32 v14, v14, v7
    s_waitcnt vmcnt(0)
    v_mul_f32 v32, v8, v16
    v_mul_f32 v33, v8, v17
    v_mul_f32 v34, v8, v18
    v_mul_f32 v35, v8, v19
    v_fmac_f32 v32, v10, v20
    v_fmac_f32 v33, v10, v21
    v_fmac_f32 v34, v10, v22
    v_fmac_f32 v35, v10, v23
    v_fmac_f32 v32, v12, v24
    v_fmac_f32 v33, v12, v25
    v_fmac_f32 v34, v12, v26
    v_fmac_f32 v35, v12, v27
    v_fmac_f32 v32, v14, v28
    v_fmac_f32 v33, v14, v29
    v_fmac_f32 v34, v14, v30
    v_fmac_f32 v35, v14, v31
    s_nop 1
    v_add_f32_dpp v32, v32, v32 row_ror:8 row_mask:0xf bank_mask:0xf
    v_add_f32_dpp v33, v33, v33 row_ror:8 row_mask:0xf bank_mask:0xf
    v_add_f32_dpp v34, v34, v34 row_ror:8 row_mask:0xf bank_mask:0xf
    v_add_f32_dpp v35, v35, v35 row_ror:8 row_mask:0xf bank_mask:0xf
    v_lshrrev_b32 v6, 4, v0
    v_lshlrev_b32 v6, 7, v6
    v_lshl_add_u32 v6, v2, 4, v6
    ds_write_b128 v6, v[32:35] offset:24832
    s_waitcnt lgkmcnt(0)
    s_barrier
    s_cmp_lg_u32 s3, 0
    s_cbranch_scc1 L_end
    v_lshlrev_b32 v6, 3, v0
    v_lshlrev_b32 v7, 2, v0
    s_mov_b64 exec, 0xffff
    ds_read_b64 v[8:9], v6 offset:24832
    ds_read_b64 v[10:11], v6 offset:24960
    ds_read_b64 v[12:13], v6 offset:25088
    ds_read_b64 v[14:15], v6 offset:25216
    ds_read_b64 v[16:17], v6 offset:25344
    ds_read_b64 v[18:19], v6 offset:25472
    ds_read_b64 v[20:21], v6 offset:25600
    ds_read_b64 v[22:23], v6 offset:25728
    ds_read_b64 v[24:25], v6 offset:25856
    ds_read_b64 v[26:27], v6 offset:25984
    ds_read_b64 v[28:29], v6 offset:26112
    ds_read_b64 v[30:31], v6 offset:26240
    ds_read_b64 v[32:33], v6 offset:26368
    ds_read_b64 v[34:35], v6 offset:26496
    ds_read_b64 v[36:37], v6 offset:26624
    ds_read_b64 v[38:39], v6 offset:26752
    s_lshl_b32 s67, s6, 10
    s_lshl_b32 s68, s7, 6
    s_add_u32 s67, s67, s68
    s_waitcnt lgkmcnt(0)
    v_add_f32 v8, v8, v10
    v_add_f32 v9, v9, v11
    v_add_f32 v8, v8, v12
    v_add_f32 v9, v9, v13
    v_add_f32 v8, v8, v14
    v_add_f32 v9, v9, v15
    v_add_f32 v8, v8, v16
    v_add_f32 v9, v9, v17
    v_add_f32 v8, v8, v18
    v_add_f32 v9, v9, v19
    v_add_f32 v8, v8, v20
    v_add_f32 v9, v9, v21
    v_add_f32 v8, v8, v22
    v_add_f32 v9, v9, v23
    v_add_f32 v8, v8, v24
    v_add_f32 v9, v9, v25
    v_add_f32 v8, v8, v26
    v_add_f32 v9, v9, v27
    v_add_f32 v8, v8, v28
    v_add_f32 v9, v9, v29
    v_add_f32 v8, v8, v30
    v_add_f32 v9, v9, v31
    v_add_f32 v8, v8, v32
    v_add_f32 v9, v9, v33
    v_add_f32 v8, v8, v34
    v_add_f32 v9, v9, v35
    v_add_f32 v8, v8, v36
    v_add_f32 v9, v9, v37
    v_add_f32 v8, v8, v38
    v_add_f32 v9, v9, v39
    v_cvt_pk_bf16_f32 v8, v8, v9
    buffer_store_dword v8, v7, s[44:47], s67 offen
L_end:
    s_endpgm
.section .rodata,"a"
.p2align 6
.amdhsa_kernel concat_heads__mha_block_cached__gqa_block_cached__decode_kernel
  .amdhsa_next_free_vgpr 256
  .amdhsa_next_free_sgpr 102
  .amdhsa_accum_offset 256
  .amdhsa_group_segment_fixed_size 0
  .amdhsa_kernarg_size 104
  .amdhsa_user_sgpr_count 2
  .amdhsa_user_sgpr_kernarg_segment_ptr 1
  .amdhsa_system_sgpr_workgroup_id_x 1
  .amdhsa_float_denorm_mode_32 3
.end_amdhsa_kernel
```
